```python
import torch

def _softmax(x, axis=-1):
    return torch.softmax(x, dim=axis)

def _gelu(x):
    return torch.nn.functional.gelu(x, approximate='tanh')

def _silu(x):
    return torch.nn.functional.silu(x)

def _sigmoid(x):
    return torch.sigmoid(x)

def _layernorm(x, axis=-1, eps=1e-05):
    m = x.mean(dim=axis, keepdim=True)
    v = x.var(dim=axis, keepdim=True, unbiased=False)
    return (x - m) / torch.sqrt(v + eps)

def _scatter_add(tgt, idx, src, axis=0):
    return tgt.clone().index_add_(axis, idx, src)

def _segment_sum(src, seg, n):
    out = torch.zeros((n,) + src.shape[1:], dtype=src.dtype)
    return out.index_add_(0, seg, src)

def _pad(x, pw):
    flat = tuple((v for pair in reversed(pw) for v in pair))
    return torch.nn.functional.pad(x, flat)
kernel_name = 'adaLN_cond__sliding_block_cached__glu_gated_geglu__decode'

def setup_inputs():

    _w = lambda a: (lambda t: t.to(torch.bfloat16) if t.is_floating_point() else t)(torch.as_tensor(a))

    def _A_setup():
        B, Sq, D = (4, 1, 576)
        Hq, Hkv, Sk, Dh = (32, 16, 4096, 128)
        assert Hq % Hkv == 0, (Hq, Hkv)
        return {'x': _w((lambda *s: torch.randn(*s, dtype=torch.bfloat16) * 0.05)(B, Sq, D)), 'k_cache': _w((lambda *s: torch.randn(*s, dtype=torch.bfloat16) * 0.8)(B, Hkv, Sk, Dh)), 'v_cache': _w((lambda *s: torch.randn(*s, dtype=torch.bfloat16) * 3.2)(B, Hkv, Sk, Dh)), 'wq': _w((lambda *s: torch.randn(*s, dtype=torch.bfloat16) * 0.8)(D, Hq * Dh) * D ** (-0.5)), 'wo': _w((lambda *s: torch.randn(*s, dtype=torch.bfloat16) * 3.2)(Hq * Dh, D) * (Hq * Dh) ** (-0.5))}
    _A_in = _A_setup()

    def _B_setup():
        B, S, Dm, Df = (4, 1, 576, 4608)
        return {'x': _w((lambda *s: torch.randn(*s, dtype=torch.bfloat16) * 0.05)(B, S, Dm)), 'w_gate': _w((lambda *s: torch.randn(*s, dtype=torch.bfloat16) * 3.2)(Dm, Df) * Dm ** (-0.5)), 'w_up': _w((lambda *s: torch.randn(*s, dtype=torch.bfloat16) * 3.2)(Dm, Df) * Dm ** (-0.5)), 'w_down': _w((lambda *s: torch.randn(*s, dtype=torch.bfloat16) * 3.2)(Df, Dm) * Df ** (-0.5))}
    _B_in = _B_setup()
    return {'A_x': _A_in['x'], 'A_k_cache': _A_in['k_cache'], 'A_v_cache': _A_in['v_cache'], 'A_wq': _A_in['wq'], 'A_wo': _A_in['wo'], 'B_x': _B_in['x'], 'B_w_gate': _B_in['w_gate'], 'B_w_up': _B_in['w_up'], 'B_w_down': _B_in['w_down'], 'c': _w((lambda *s: torch.randn(*s, dtype=torch.bfloat16) * 0.4)(4, 576) * 8.0), 'w_mod': _w((lambda *s: torch.randn(*s, dtype=torch.bfloat16) * 0.4)(576, 6 * 576) * 576 ** (-0.5) * 8.0)}

def reference(A_x, A_k_cache, A_v_cache, A_wq, A_wo, B_x, B_w_gate, B_w_up, B_w_down, c, w_mod):

    def _A_ref(x, k_cache, v_cache, wq, wo):
        B, Sq, D = x.shape
        Hq, Dh = (32, 128)
        Hkv, Sk = (k_cache.shape[1], k_cache.shape[2])
        W = min(4096, max(256, Sk // 4))
        rep = Hq // Hkv
        q = (lambda x, *d: x.permute(*d))((x @ wq).reshape(B, Sq, Hq, Dh), 0, 2, 1, 3)
        k = (lambda x, n, axis: torch.repeat_interleave(x, n, dim=axis))(k_cache[:, :, Sk - W:, :], rep, axis=1)
        v = (lambda x, n, axis: torch.repeat_interleave(x, n, dim=axis))(v_cache[:, :, Sk - W:, :], rep, axis=1)
        scores = torch.einsum('bhqd,bhkd->bhqk', q, k) * Dh ** (-0.5)
        p = _softmax(scores, axis=-1)
        o = torch.einsum('bhqk,bhkd->bhqd', p, v)
        return (lambda x, *d: x.permute(*d))(o, 0, 2, 1, 3).reshape(B, Sq, Hq * Dh) @ wo

    def _B_ref(x, w_gate, w_up, w_down):
        g = torch.einsum('bsd,df->bsf', x, w_gate)
        u = torch.einsum('bsd,df->bsf', x, w_up)
        h = _gelu(g) * u
        return torch.einsum('bsf,fd->bsd', h, w_down)
    x = A_x
    mod = (_silu(c) @ w_mod).reshape(c.shape[0], 6, 1, -1)
    sa, ca, ga, sb, cb, gb = (mod[:, 0].clone(), mod[:, 1].clone(), mod[:, 2].clone(), mod[:, 3].clone(), mod[:, 4].clone(), mod[:, 5].clone())
    h = _layernorm(x, axis=-1) * (1 + ca) + sa
    x = x + ga * _A_ref(h, A_k_cache, A_v_cache, A_wq, A_wo)
    h = _layernorm(x, axis=-1) * (1 + cb) + sb
    x = x + gb * _B_ref(h, B_w_gate, B_w_up, B_w_down)
    return x
```

```asm
; @launch grid=(256,1,1) block=(512,1,1) lds=102400
.amdgcn_target "amdgcn-amd-amdhsa--gfx950"
.text
.p2align 12
.set CODE_SLICE, 3072
.globl adaLN_cond__sliding_block_cached__glu_gated_geglu__decode_kernel
.p2align 8
.type adaLN_cond__sliding_block_cached__glu_gated_geglu__decode_kernel,@function
adaLN_cond__sliding_block_cached__glu_gated_geglu__decode_kernel:
    s_load_dwordx16 s[8:23], s[0:1], 0
    s_load_dwordx8 s[24:31], s[0:1], 64
    s_load_dwordx4 s[32:35], s[0:1], 96
    v_lshrrev_b32 v1, 6, v0
    s_cmp_ge_u32 s2, 256
    v_readfirstlane_b32 s3, v1
    s_cbranch_scc1 L_exit
    v_and_b32 v0, 63, v0
    s_and_b32 s4, s2, 7
    s_lshr_b32 s5, s2, 3
    s_cmp_lt_u32 s3, 4
    s_cbranch_scc1 L_kv
    s_sub_u32 s6, s5, 12
    s_sub_u32 s7, 37, s5
    s_cmp_lt_u32 s5, 18
    s_cselect_b32 s6, s6, s7
    s_mul_i32 s6, s6, 7
    s_add_u32 s101, s6, s4
    s_cmp_eq_u32 s5, 30
    s_cselect_b32 s7, 3, 1
    s_sub_u32 s101, s101, s7
    s_cmp_lt_u32 s4, s7
    s_cselect_b32 s101, 99, s101
    s_cmp_lt_u32 s2, 96
    s_cselect_b32 s101, 0, s101
    s_cmp_lt_u32 s3, 7
    s_cbranch_scc1 L_w
    v_mov_b32 v12, 0
    v_mov_b32 v13, 0
    v_mov_b32 v14, 0
    v_mov_b32 v15, 0
    v_lshlrev_b32 v1, 4, v0
    ds_write_b128 v1, v[12:15] offset:18496
    s_getpc_b64 s[52:53]
L_pc:
    s_and_b32 s54, s5, 7
    s_mul_i32 s54, s54, CODE_SLICE
    s_add_u32 s54, s54, 1024-(L_pc-adaLN_cond__sliding_block_cached__glu_gated_geglu__decode_kernel)
    s_add_u32 s52, s52, s54
    s_addc_u32 s53, s53, 0
    global_load_dwordx4 v[24:27], v1, s[52:53] offset:0
    global_load_dwordx4 v[24:27], v1, s[52:53] offset:1024
    global_load_dwordx4 v[24:27], v1, s[52:53] offset:2048
    v_mov_b32 v14, 1
    s_waitcnt lgkmcnt(0)
    s_load_dword s100, s[34:35], 0
    s_barrier
    s_branch L_comm
L_w:
    s_sub_u32 s7, s3, 4
    v_mov_b32 v15, 0
    v_mov_b32 v14, 1
    s_cmp_lt_u32 s101, 54
    s_cbranch_scc0 L_w_ne
    s_mul_i32 s58, s101, 3641
    s_mov_b32 s6, s101
    s_lshr_b32 s58, s58, 16
    s_mul_i32 s53, s58, 18
    s_sub_u32 s6, s6, s53
    s_lshl_b32 s53, s4, 2
    s_and_b32 s54, s5, 3
    s_add_u32 s53, s53, s54
    s_lshl_b32 s53, s53, 1
    s_lshr_b32 s54, s5, 2
    s_cmp_lt_u32 s2, 96
    s_cselect_b32 s53, s53, s6
    s_cselect_b32 s58, s54, s58
    s_movk_i32 s56, 6912
    s_cmovk_i32 s56, 8192
    v_and_b32 v5, 8, v0
    v_lshrrev_b32 v6, 4, v0
    v_lshlrev_b32 v6, 1, v6
    v_add_u32 v5, v5, v6
    v_mul_u32_u24 v1, s56, v5
    v_and_b32 v5, 7, v0
    v_lshlrev_b32 v5, 2, v5
    v_add_lshl_u32 v1, v1, v5, 2
    s_mul_i32 s58, s58, 3
    s_add_u32 s58, s58, s7
    s_lshl_b32 s58, s58, 6
    s_mul_i32 s52, s58, s56
    s_lshl_b32 s53, s53, 7
    s_add_u32 s52, s52, s53
    s_mul_i32 s38, s56, 576
    s_mov_b32 s39, 0x20000
    s_movk_i32 s50, 4608
    s_mov_b32 s51, 0x20000
    s_lshl_b32 s57, s58, 1
    v_lshlrev_b32 v12, 1, v0
    s_cmp_lt_u32 s2, 96
    s_waitcnt lgkmcnt(0)
    s_cselect_b64 s[36:37], s[14:15], s[28:29]
    s_cselect_b64 s[48:49], s[8:9], s[26:27]
    buffer_load_ushort v56, v12, s[48:51], s57 offen offset:0
    buffer_load_ushort v57, v12, s[48:51], s57 offen offset:1152
    buffer_load_ushort v58, v12, s[48:51], s57 offen offset:2304
    buffer_load_ushort v59, v12, s[48:51], s57 offen offset:3456
    s_cbranch_scc1 L_w_q0
    buffer_load_dwordx4 v[96:99], v1, s[36:39], s52 offen nt
    s_add_u32 s52, s52, s56
    buffer_load_dwordx4 v[100:103], v1, s[36:39], s52 offen nt
    s_add_u32 s52, s52, s56
    buffer_load_dwordx4 v[104:107], v1, s[36:39], s52 offen nt
    s_add_u32 s52, s52, s56
    buffer_load_dwordx4 v[108:111], v1, s[36:39], s52 offen nt
    s_add_u32 s52, s52, s56
    buffer_load_dwordx4 v[112:115], v1, s[36:39], s52 offen nt
    s_add_u32 s52, s52, s56
    buffer_load_dwordx4 v[116:119], v1, s[36:39], s52 offen nt
    s_add_u32 s52, s52, s56
    buffer_load_dwordx4 v[120:123], v1, s[36:39], s52 offen nt
    s_add_u32 s52, s52, s56
    buffer_load_dwordx4 v[124:127], v1, s[36:39], s52 offen nt
    s_load_dword s100, s[34:35], 0
    s_barrier
    s_branch L_w_early
L_w_q0:
    buffer_load_dwordx4 v[96:99], v1, s[36:39], s52 offen offset:0 nt
    buffer_load_dwordx4 v[128:131], v1, s[36:39], s52 offen offset:128 nt
    s_add_u32 s52, s52, s56
    buffer_load_dwordx4 v[100:103], v1, s[36:39], s52 offen offset:0 nt
    buffer_load_dwordx4 v[132:135], v1, s[36:39], s52 offen offset:128 nt
    s_add_u32 s52, s52, s56
    buffer_load_dwordx4 v[104:107], v1, s[36:39], s52 offen offset:0 nt
    buffer_load_dwordx4 v[136:139], v1, s[36:39], s52 offen offset:128 nt
    s_add_u32 s52, s52, s56
    buffer_load_dwordx4 v[108:111], v1, s[36:39], s52 offen offset:0 nt
    buffer_load_dwordx4 v[140:143], v1, s[36:39], s52 offen offset:128 nt
    s_add_u32 s52, s52, s56
    s_load_dword s100, s[34:35], 0
    s_barrier
    s_branch L_w_q1
L_w_ne:
    s_waitcnt lgkmcnt(0)
    s_load_dword s100, s[34:35], 0
    s_barrier
    s_branch L_w_l0
L_kv:
    s_lshr_b32 s6, s5, 4
    s_lshl_b32 s7, s4, 1
    s_add_u32 s6, s6, s7
    s_bfe_u32 s7, s5, 0x20002
    s_lshl_b32 s52, s7, 4
    s_add_u32 s52, s52, s6
    s_lshl_b32 s52, s52, 20
    s_and_b32 s53, s5, 3
    s_lshl_b32 s53, s53, 2
    s_add_u32 s53, s53, s3
    s_add_u32 s53, s53, 48
    s_lshl_b32 s53, s53, 14
    s_add_u32 s52, s52, s53
    v_lshrrev_b32 v15, 4, v0
    v_and_b32 v14, 15, v0
    v_lshlrev_b32 v13, 8, v15
    v_xor_b32 v7, v14, v15
    v_xor_b32 v8, 4, v7
    v_xor_b32 v9, 8, v7
    v_xor_b32 v10, 12, v7
    v_lshl_add_u32 v1, v7, 4, v13
    v_lshl_add_u32 v2, v8, 4, v13
    v_lshl_add_u32 v3, v9, 4, v13
    v_lshl_add_u32 v4, v10, 4, v13
    s_lshl_b32 s48, s3, 14
    s_add_u32 s48, s48, 36864
    s_add_u32 s54, s5, s3
    s_and_b32 s54, s54, 3
    s_lshl_b32 s54, s54, 12
    s_xor_b32 s55, s54, 0x1000
    s_xor_b32 s56, s54, 0x2000
    s_xor_b32 s57, s54, 0x3000
    s_movk_i32 s38, 0x4000
    s_mov_b32 s39, 0x20000
    s_mov_b32 m0, s48
    s_waitcnt lgkmcnt(0)
    s_add_u32 s36, s10, s52
    s_addc_u32 s37, s11, 0
    buffer_load_dwordx4 v1, s[36:39], s54 offen offset:0 nt lds
    s_load_dword s100, s[34:35], 0
    s_barrier
L_firstkb:
    s_add_u32 s40, s12, s52
    s_addc_u32 s41, s13, 0
    s_movk_i32 s42, 0x4000
    s_mov_b32 s43, 0x20000
    v_lshlrev_b32 v5, 10, v15
    v_lshl_add_u32 v5, v14, 4, v5
    v_lshrrev_b32 v6, 3, v14
    v_lshlrev_b32 v52, 4, v6
    v_lshlrev_b32 v6, 8, v6
    v_lshl_add_u32 v6, v15, 4, v6
    v_lshlrev_b32 v13, 8, v14
    v_add_u32 v13, s48, v13
    v_lshl_add_u32 v7, v7, 4, v13
    v_lshl_add_u32 v8, v8, 4, v13
    v_lshl_add_u32 v9, v9, 4, v13
    v_lshl_add_u32 v10, v10, 4, v13
    v_and_b32 v13, 1, v0
    v_lshlrev_b32 v13, 4, v13
    v_mov_b32 v48, 0xffff
    v_lshlrev_b32 v48, v13, v48
    v_bfe_u32 v13, v0, 1, 2
    v_cmp_eq_u32 vcc, 0, v13
    s_nop 1
    v_cndmask_b32 v11, 0, v48, vcc
    v_cmp_eq_u32 vcc, 1, v13
    s_nop 1
    v_cndmask_b32 v12, 0, v48, vcc
    v_cmp_eq_u32 vcc, 3, v13
    s_nop 1
    v_cndmask_b32 v14, 0, v48, vcc
    v_cmp_eq_u32 vcc, 2, v13
    s_nop 1
    v_cndmask_b32 v13, 0, v48, vcc
    v_mov_b32 v15, 0
    v_mov_b32 v192, 1
    v_mov_b32 v193, 0xff
    s_lshl_b32 s60, s3, 2
    v_add_u32 v53, s60, v52
    v_lshrrev_b32 v54, 5, v0
    v_lshlrev_b32 v54, 4, v54
    v_add_u32 v55, s60, v54
    v_lshlrev_b32 v56, 4, v0
    s_lshl_b32 s62, s3, 10
    v_add_u32 v57, s62, v56
    v_lshlrev_b32 v58, 1, v0
    s_lshl_b32 s61, s4, 5
    s_add_u32 s61, s61, s5
    s_lshl_b32 s58, s61, 7
    s_lshl_b32 s62, s3, 5
    s_add_u32 s58, s58, s62
    s_add_u32 s58, s58, 299008
    s_lshl_b32 s59, s61, 10
    s_add_u32 s59, s59, 331776
    s_mov_b32 s18, 0x3db504f3
    s_mov_b32 s19, 0x3db504f3
    s_mov_b32 s50, 0x3fb8aa3b
    s_mov_b32 s51, 0x3fb8aa3b
    s_cmp_lt_u32 s2, 0
    s_cselect_b32 s49, -1, 0
    s_mov_b32 s44, s34
    s_mov_b32 s45, s35
    s_mov_b32 s46, 8388608
    s_mov_b32 s47, 0x20000
    s_waitcnt lgkmcnt(0)
    s_add_u32 s100, s100, 0x01010101
    s_bfe_u32 s96, s100, 0x80000
    s_bfe_u32 s97, s100, 0x80008
    s_bfe_u32 s98, s100, 0x80010
    s_bfe_u32 s99, s100, 0x80018
    s_waitcnt vmcnt(0)
    buffer_load_dwordx4 v2, s[36:39], s54 offen offset:1024 nt lds
    s_mov_b64 exec, 1
    ds_add_u32 v15, v192 offset:19036
    s_mov_b64 exec, -1
    buffer_load_dwordx4 v3, s[36:39], s54 offen offset:2048 nt lds
    buffer_load_dwordx4 v4, s[36:39], s54 offen offset:3072 nt lds
    s_add_u32 m0, s48, 4096
    s_waitcnt vmcnt(3)
    buffer_load_dwordx4 v1, s[36:39], s55 offen offset:0 nt lds
    s_waitcnt vmcnt(3)
    buffer_load_dwordx4 v2, s[36:39], s55 offen offset:1024 nt lds
    s_waitcnt vmcnt(3)
    buffer_load_dwordx4 v3, s[36:39], s55 offen offset:2048 nt lds
    s_waitcnt vmcnt(3)
    buffer_load_dwordx4 v4, s[36:39], s55 offen offset:3072 nt lds
    s_add_u32 m0, s48, 8192
    s_waitcnt vmcnt(3)
    buffer_load_dwordx4 v1, s[36:39], s56 offen offset:0 nt lds
    s_mov_b64 exec, 1
    ds_add_u32 v15, v192 offset:19020
    s_mov_b64 exec, -1
    s_waitcnt vmcnt(3)
    buffer_load_dwordx4 v2, s[36:39], s56 offen offset:1024 nt lds
    s_waitcnt vmcnt(3)
    buffer_load_dwordx4 v3, s[36:39], s56 offen offset:2048 nt lds
    s_mov_b64 exec, 1
    ds_add_u32 v15, v192 offset:19052
    s_mov_b64 exec, -1
    s_waitcnt vmcnt(3)
    buffer_load_dwordx4 v4, s[36:39], s56 offen offset:3072 nt lds
    s_add_u32 m0, s48, 12288
    s_waitcnt vmcnt(3)
    buffer_load_dwordx4 v1, s[36:39], s57 offen offset:0 nt lds
    s_waitcnt vmcnt(3)
    buffer_load_dwordx4 v2, s[36:39], s57 offen offset:1024 nt lds
    s_waitcnt vmcnt(3)
    buffer_load_dwordx4 v3, s[36:39], s57 offen offset:2048 nt lds
    s_waitcnt vmcnt(3)
    buffer_load_dwordx4 v4, s[36:39], s57 offen offset:3072 nt lds
    ds_read_b32 v48, v15 offset:19048
    s_waitcnt lgkmcnt(0)
    v_cmp_ne_u32 vcc, s49, v48
    s_cbranch_vccnz Lt_1
    s_waitcnt vmcnt(3)
Lt_1:
    s_waitcnt vmcnt(6)
    buffer_load_dwordx4 v[64:67], v5, s[40:43], s54 offen offset:0 nt
    ds_read_b32 v48, v15 offset:19048
    s_waitcnt lgkmcnt(0)
    v_cmp_ne_u32 vcc, s49, v48
    s_cbranch_vccnz Lt_2
    s_waitcnt vmcnt(3)
Lt_2:
    s_waitcnt vmcnt(6)
    buffer_load_dwordx4 v[68:71], v5, s[40:43], s54 offen offset:256 nt
    ds_read_b32 v48, v15 offset:19048
    s_waitcnt lgkmcnt(0)
    v_cmp_ne_u32 vcc, s49, v48
    s_cbranch_vccnz Lt_3
    s_waitcnt vmcnt(3)
Lt_3:
    s_waitcnt vmcnt(6)
    buffer_load_dwordx4 v[72:75], v5, s[40:43], s54 offen offset:512 nt
    ds_read_b32 v48, v15 offset:19048
    s_waitcnt lgkmcnt(0)
    v_cmp_ne_u32 vcc, s49, v48
    s_cbranch_vccnz Lt_4
    s_waitcnt vmcnt(3)
Lt_4:
    s_waitcnt vmcnt(6)
    buffer_load_dwordx4 v[76:79], v5, s[40:43], s54 offen offset:768 nt
    ds_read_b32 v48, v15 offset:19048
    s_waitcnt lgkmcnt(0)
    v_cmp_ne_u32 vcc, s49, v48
    s_cbranch_vccnz Lt_5
    s_waitcnt vmcnt(3)
Lt_5:
    s_waitcnt vmcnt(6)
    buffer_load_dwordx4 v[80:83], v5, s[40:43], s55 offen offset:0 nt
    ds_read_b32 v48, v15 offset:19048
    s_waitcnt lgkmcnt(0)
    v_cmp_ne_u32 vcc, s49, v48
    s_cbranch_vccnz Lt_6
    s_waitcnt vmcnt(3)
Lt_6:
    s_waitcnt vmcnt(6)
    buffer_load_dwordx4 v[84:87], v5, s[40:43], s55 offen offset:256 nt
    ds_read_b32 v48, v15 offset:19048
    s_waitcnt lgkmcnt(0)
    v_cmp_ne_u32 vcc, s49, v48
    s_cbranch_vccnz Lt_7
    s_waitcnt vmcnt(3)
Lt_7:
    s_waitcnt vmcnt(6)
    buffer_load_dwordx4 v[88:91], v5, s[40:43], s55 offen offset:512 nt
    ds_read_b32 v48, v15 offset:19048
    s_waitcnt lgkmcnt(0)
    v_cmp_ne_u32 vcc, s49, v48
    s_cbranch_vccnz Lt_8
    s_waitcnt vmcnt(3)
Lt_8:
    s_waitcnt vmcnt(6)
    buffer_load_dwordx4 v[92:95], v5, s[40:43], s55 offen offset:768 nt
    ds_read_b32 v48, v15 offset:19048
    s_waitcnt lgkmcnt(0)
    v_cmp_ne_u32 vcc, s49, v48
    s_cbranch_vccnz Lt_9
    s_waitcnt vmcnt(3)
Lt_9:
    s_waitcnt vmcnt(6)
    buffer_load_dwordx4 v[96:99], v5, s[40:43], s56 offen offset:0 nt
    ds_read_b32 v48, v15 offset:19048
    s_waitcnt lgkmcnt(0)
    v_cmp_ne_u32 vcc, s49, v48
    s_cbranch_vccnz Lt_10
    s_waitcnt vmcnt(3)
Lt_10:
    s_waitcnt vmcnt(6)
    buffer_load_dwordx4 v[100:103], v5, s[40:43], s56 offen offset:256 nt
    ds_read_b32 v48, v15 offset:19048
    s_waitcnt lgkmcnt(0)
    v_cmp_ne_u32 vcc, s49, v48
    s_cbranch_vccnz Lt_11
    s_waitcnt vmcnt(3)
Lt_11:
    s_waitcnt vmcnt(6)
    buffer_load_dwordx4 v[104:107], v5, s[40:43], s56 offen offset:512 nt
    ds_read_b32 v48, v15 offset:19048
    s_waitcnt lgkmcnt(0)
    v_cmp_ne_u32 vcc, s49, v48
    s_cbranch_vccnz Lt_12
    s_waitcnt vmcnt(3)
Lt_12:
    s_waitcnt vmcnt(6)
    buffer_load_dwordx4 v[108:111], v5, s[40:43], s56 offen offset:768 nt
    ds_read_b32 v48, v15 offset:19048
    s_waitcnt lgkmcnt(0)
    v_cmp_ne_u32 vcc, s49, v48
    s_cbranch_vccnz Lt_13
    s_waitcnt vmcnt(3)
Lt_13:
    s_waitcnt vmcnt(6)
    buffer_load_dwordx4 v[112:115], v5, s[40:43], s57 offen offset:0 nt
    ds_read_b32 v48, v15 offset:19048
    s_waitcnt lgkmcnt(0)
    v_cmp_ne_u32 vcc, s49, v48
    s_cbranch_vccnz Lt_14
    s_waitcnt vmcnt(3)
Lt_14:
    s_waitcnt vmcnt(6)
    buffer_load_dwordx4 v[116:119], v5, s[40:43], s57 offen offset:256 nt
    ds_read_b32 v48, v15 offset:19048
    ds_read_b128 v[128:131], v7 offset:0
    ds_read_b128 v[132:135], v8 offset:0
    ds_read_b128 v[136:139], v9 offset:0
    ds_read_b128 v[140:143], v10 offset:0
    ds_read_b128 v[144:147], v7 offset:4096
    ds_read_b128 v[148:151], v8 offset:4096
    ds_read_b128 v[152:155], v9 offset:4096
    ds_read_b128 v[156:159], v10 offset:4096
    ds_read_b128 v[160:163], v7 offset:8192
    ds_read_b128 v[164:167], v8 offset:8192
    ds_read_b128 v[168:171], v9 offset:8192
    ds_read_b128 v[172:175], v10 offset:8192
    ds_read_b128 v[176:179], v7 offset:12288
    ds_read_b128 v[180:183], v8 offset:12288
    ds_read_b128 v[184:187], v9 offset:12288
    ds_read_b128 v[188:191], v10 offset:12288
    s_waitcnt lgkmcnt(0)
    v_cmp_ne_u32 vcc, s49, v48
    s_cbranch_vccnz Lt_15
    s_waitcnt vmcnt(3)
Lt_15:
    s_waitcnt vmcnt(6)
    buffer_load_dwordx4 v[120:123], v5, s[40:43], s57 offen offset:512 nt
    ds_read_b32 v48, v15 offset:19048
    s_waitcnt lgkmcnt(0)
    v_cmp_ne_u32 vcc, s49, v48
    s_cbranch_vccnz Lt_16
    s_waitcnt vmcnt(3)
Lt_16:
    s_waitcnt vmcnt(6)
    buffer_load_dwordx4 v[124:127], v5, s[40:43], s57 offen offset:768 nt
    s_mov_b64 exec, 1
    ds_add_u32 v15, v192 offset:19020
    s_mov_b64 exec, -1
Lsp_17:
    ds_read_b32 v48, v15 offset:19048
    s_waitcnt lgkmcnt(0)
    v_cmp_gt_u32 vcc, 1, v48
    s_cbranch_vccnz Lsp_17
    ds_read_b128 v[16:19], v6 offset:19136
    ds_read_b128 v[20:23], v6 offset:19200
    ds_read_b128 v[24:27], v6 offset:19264
    ds_read_b128 v[28:31], v6 offset:19328
    v_readfirstlane_b32 s53, v48
    s_waitcnt lgkmcnt(0)
    v_mfma_f32_16x16x32_bf16 v[32:35], v[128:131], v[16:19], 0
    v_mfma_f32_16x16x32_bf16 v[32:35], v[132:135], v[20:23], v[32:35]
    v_mfma_f32_16x16x32_bf16 v[32:35], v[136:139], v[24:27], v[32:35]
    v_mfma_f32_16x16x32_bf16 v[32:35], v[140:143], v[28:31], v[32:35]
    v_mfma_f32_16x16x32_bf16 v[36:39], v[144:147], v[16:19], 0
    v_mfma_f32_16x16x32_bf16 v[36:39], v[148:151], v[20:23], v[36:39]
    v_mfma_f32_16x16x32_bf16 v[36:39], v[152:155], v[24:27], v[36:39]
    v_mfma_f32_16x16x32_bf16 v[36:39], v[156:159], v[28:31], v[36:39]
    v_mfma_f32_16x16x32_bf16 v[40:43], v[160:163], v[16:19], 0
    v_mfma_f32_16x16x32_bf16 v[40:43], v[164:167], v[20:23], v[40:43]
    v_mfma_f32_16x16x32_bf16 v[40:43], v[168:171], v[24:27], v[40:43]
    v_mfma_f32_16x16x32_bf16 v[40:43], v[172:175], v[28:31], v[40:43]
    v_mfma_f32_16x16x32_bf16 v[44:47], v[176:179], v[16:19], 0
    v_mfma_f32_16x16x32_bf16 v[44:47], v[180:183], v[20:23], v[44:47]
    v_mfma_f32_16x16x32_bf16 v[44:47], v[184:187], v[24:27], v[44:47]
    v_mfma_f32_16x16x32_bf16 v[44:47], v[188:191], v[28:31], v[44:47]
    v_cvt_pk_bf16_f32 v16, v32, v33
    v_cvt_pk_bf16_f32 v17, v34, v35
    v_cvt_pk_bf16_f32 v18, v36, v37
    v_cvt_pk_bf16_f32 v19, v38, v39
    v_cvt_pk_bf16_f32 v20, v40, v41
    v_cvt_pk_bf16_f32 v21, v42, v43
    s_nop 1
    v_cvt_pk_bf16_f32 v22, v44, v45
    v_cvt_pk_bf16_f32 v23, v46, v47
    v_and_b32 v33, 0xffff0000, v16
    v_lshlrev_b32 v32, 16, v16
    v_and_b32 v35, 0xffff0000, v17
    v_lshlrev_b32 v34, 16, v17
    v_and_b32 v37, 0xffff0000, v18
    v_lshlrev_b32 v36, 16, v18
    v_and_b32 v39, 0xffff0000, v19
    v_lshlrev_b32 v38, 16, v19
    v_and_b32 v41, 0xffff0000, v20
    v_lshlrev_b32 v40, 16, v20
    v_and_b32 v43, 0xffff0000, v21
    v_lshlrev_b32 v42, 16, v21
    v_and_b32 v45, 0xffff0000, v22
    v_lshlrev_b32 v44, 16, v22
    v_and_b32 v47, 0xffff0000, v23
    v_lshlrev_b32 v46, 16, v23
    v_pk_mul_f32 v[32:33], v[32:33], s[18:19]
    v_pk_mul_f32 v[34:35], v[34:35], s[18:19]
    v_pk_mul_f32 v[36:37], v[36:37], s[18:19]
    v_pk_mul_f32 v[38:39], v[38:39], s[18:19]
    v_pk_mul_f32 v[40:41], v[40:41], s[18:19]
    v_pk_mul_f32 v[42:43], v[42:43], s[18:19]
    v_pk_mul_f32 v[44:45], v[44:45], s[18:19]
    v_pk_mul_f32 v[46:47], v[46:47], s[18:19]
    v_cvt_pk_bf16_f32 v16, v32, v33
    v_cvt_pk_bf16_f32 v17, v34, v35
    v_cvt_pk_bf16_f32 v18, v36, v37
    v_cvt_pk_bf16_f32 v19, v38, v39
    v_cvt_pk_bf16_f32 v20, v40, v41
    v_cvt_pk_bf16_f32 v21, v42, v43
    v_cvt_pk_bf16_f32 v22, v44, v45
    v_cvt_pk_bf16_f32 v23, v46, v47
    v_and_b32 v33, 0xffff0000, v16
    v_lshlrev_b32 v32, 16, v16
    v_and_b32 v35, 0xffff0000, v17
    v_lshlrev_b32 v34, 16, v17
    v_and_b32 v37, 0xffff0000, v18
    v_lshlrev_b32 v36, 16, v18
    v_and_b32 v39, 0xffff0000, v19
    v_lshlrev_b32 v38, 16, v19
    v_and_b32 v41, 0xffff0000, v20
    v_lshlrev_b32 v40, 16, v20
    v_and_b32 v43, 0xffff0000, v21
    v_lshlrev_b32 v42, 16, v21
    v_and_b32 v45, 0xffff0000, v22
    v_lshlrev_b32 v44, 16, v22
    v_and_b32 v47, 0xffff0000, v23
    v_lshlrev_b32 v46, 16, v23
    v_max3_f32 v48, v32, v33, v34
    v_max3_f32 v48, v48, v35, v36
    v_max3_f32 v48, v48, v37, v38
    v_max3_f32 v48, v48, v39, v40
    v_max3_f32 v48, v48, v41, v42
    v_max3_f32 v48, v48, v43, v44
    v_max3_f32 v48, v48, v45, v46
    v_max_f32 v48, v48, v47
    v_mov_b32 v49, v48
    s_nop 1
    v_permlane16_swap_b32 v48, v49
    v_max_f32 v48, v48, v49
    v_mov_b32 v49, v48
    s_nop 1
    v_permlane32_swap_b32 v48, v49
    v_max_f32 v48, v48, v49
    s_mov_b32 exec_lo, 0x101
    s_mov_b32 exec_hi, 0
    ds_write_b32 v53, v48 offset:19072
    s_mov_b64 exec, 1
    ds_add_u32 v15, v192 offset:19024
    s_mov_b64 exec, -1
    v_mul_f32 v50, 0xbfb8aa3b, v48
    v_pk_fma_f32 v[32:33], v[32:33], s[50:51], v[50:51] op_sel_hi:[1,1,0]
    v_pk_fma_f32 v[34:35], v[34:35], s[50:51], v[50:51] op_sel_hi:[1,1,0]
    v_pk_fma_f32 v[36:37], v[36:37], s[50:51], v[50:51] op_sel_hi:[1,1,0]
    v_pk_fma_f32 v[38:39], v[38:39], s[50:51], v[50:51] op_sel_hi:[1,1,0]
    v_pk_fma_f32 v[40:41], v[40:41], s[50:51], v[50:51] op_sel_hi:[1,1,0]
    v_pk_fma_f32 v[42:43], v[42:43], s[50:51], v[50:51] op_sel_hi:[1,1,0]
    v_pk_fma_f32 v[44:45], v[44:45], s[50:51], v[50:51] op_sel_hi:[1,1,0]
    v_pk_fma_f32 v[46:47], v[46:47], s[50:51], v[50:51] op_sel_hi:[1,1,0]
    v_exp_f32 v32, v32
    v_exp_f32 v33, v33
    v_exp_f32 v34, v34
    v_exp_f32 v35, v35
    v_exp_f32 v36, v36
    v_exp_f32 v37, v37
    v_exp_f32 v38, v38
    v_exp_f32 v39, v39
    v_exp_f32 v40, v40
    v_exp_f32 v41, v41
    v_exp_f32 v42, v42
    v_exp_f32 v43, v43
    v_exp_f32 v44, v44
    v_exp_f32 v45, v45
    v_exp_f32 v46, v46
    v_exp_f32 v47, v47
    v_pk_add_f32 v[50:51], v[32:33], v[34:35]
    v_pk_add_f32 v[50:51], v[50:51], v[36:37]
    v_pk_add_f32 v[50:51], v[50:51], v[38:39]
    v_pk_add_f32 v[50:51], v[50:51], v[40:41]
    v_pk_add_f32 v[50:51], v[50:51], v[42:43]
    v_pk_add_f32 v[50:51], v[50:51], v[44:45]
    v_pk_add_f32 v[50:51], v[50:51], v[46:47]
    v_add_f32 v50, v50, v51
    v_mov_b32 v51, v50
    s_nop 1
    v_permlane16_swap_b32 v50, v51
    v_add_f32 v50, v50, v51
    v_mov_b32 v51, v50
    s_nop 1
    v_permlane32_swap_b32 v50, v51
    v_add_f32 v50, v50, v51
Lsp_18:
    ds_read_b32 v49, v15 offset:19024
    s_waitcnt lgkmcnt(0)
    v_cmp_gt_u32 vcc, 4, v49
    s_cbranch_vccnz Lsp_18
    ds_read_b128 v[16:19], v52 offset:19072
    ds_read_b128 v[20:23], v54 offset:19072
    ds_read_b32 v60, v55 offset:19072
    v_cvt_pk_bf16_f32 v32, v32, v32
    v_and_b32 v128, v32, v11
    v_and_b32 v129, v32, v12
    v_and_b32 v130, v32, v13
    v_and_b32 v131, v32, v14
    v_cvt_pk_bf16_f32 v33, v33, v33
    v_and_b32 v132, v33, v11
    v_and_b32 v133, v33, v12
    v_and_b32 v134, v33, v13
    v_and_b32 v135, v33, v14
    s_waitcnt lgkmcnt(0)
    v_max3_f32 v16, v16, v17, v18
    v_max3_f32 v20, v20, v21, v22
    v_max_f32 v16, v16, v19
    v_max_f32 v20, v20, v23
    v_sub_f32 v48, v48, v16
    v_sub_f32 v60, v60, v20
    v_mul_f32 v48, s50, v48
    v_mul_f32 v60, s50, v60
    v_exp_f32 v48, v48
    v_exp_f32 v60, v60
    v_mul_f32 v17, v48, v50
    v_bfi_b32 v16, v193, s96, v16
    v_bfi_b32 v17, v193, s97, v17
    v_bfi_b32 v18, v193, s98, v18
    v_bfi_b32 v19, v193, s99, v19
    s_mov_b32 exec_lo, 0x101
    s_mov_b32 exec_hi, 0
    s_cmp_eq_u32 s53, 2
    s_cbranch_scc1 L_ml_loc
    buffer_store_dwordx4 v[16:19], v58, s[44:47], s58 offen sc1
    s_branch L_ml_done
L_ml_loc:
    buffer_store_dwordx4 v[16:19], v58, s[44:47], s58 offen
L_ml_done:
    s_mov_b64 exec, -1
    v_cvt_pk_bf16_f32 v34, v34, v34
    v_and_b32 v136, v34, v11
    v_and_b32 v137, v34, v12
    v_and_b32 v138, v34, v13
    v_and_b32 v139, v34, v14
    s_waitcnt vmcnt(16)
    v_mfma_f32_16x16x32_bf16 v[24:27], v[128:131], v[64:67], 0
    v_cvt_pk_bf16_f32 v35, v35, v35
    v_and_b32 v140, v35, v11
    v_and_b32 v141, v35, v12
    v_and_b32 v142, v35, v13
    v_and_b32 v143, v35, v14
    s_waitcnt vmcnt(15)
    v_mfma_f32_16x16x32_bf16 v[24:27], v[132:135], v[68:71], v[24:27]
    v_cvt_pk_bf16_f32 v36, v36, v36
    v_and_b32 v144, v36, v11
    v_and_b32 v145, v36, v12
    v_and_b32 v146, v36, v13
    v_and_b32 v147, v36, v14
    s_waitcnt vmcnt(14)
    v_mfma_f32_16x16x32_bf16 v[24:27], v[136:139], v[72:75], v[24:27]
    v_cvt_pk_bf16_f32 v37, v37, v37
    v_and_b32 v148, v37, v11
    v_and_b32 v149, v37, v12
    v_and_b32 v150, v37, v13
    v_and_b32 v151, v37, v14
    s_waitcnt vmcnt(13)
    v_mfma_f32_16x16x32_bf16 v[24:27], v[140:143], v[76:79], v[24:27]
    v_cvt_pk_bf16_f32 v38, v38, v38
    v_and_b32 v152, v38, v11
    v_and_b32 v153, v38, v12
    v_and_b32 v154, v38, v13
    v_and_b32 v155, v38, v14
    s_waitcnt vmcnt(12)
    v_mfma_f32_16x16x32_bf16 v[24:27], v[144:147], v[80:83], v[24:27]
    v_cvt_pk_bf16_f32 v39, v39, v39
    v_and_b32 v156, v39, v11
    v_and_b32 v157, v39, v12
    v_and_b32 v158, v39, v13
    v_and_b32 v159, v39, v14
    s_waitcnt vmcnt(11)
    v_mfma_f32_16x16x32_bf16 v[24:27], v[148:151], v[84:87], v[24:27]
    v_cvt_pk_bf16_f32 v40, v40, v40
    v_and_b32 v160, v40, v11
    v_and_b32 v161, v40, v12
    v_and_b32 v162, v40, v13
    v_and_b32 v163, v40, v14
    s_waitcnt vmcnt(10)
    v_mfma_f32_16x16x32_bf16 v[24:27], v[152:155], v[88:91], v[24:27]
    v_cvt_pk_bf16_f32 v41, v41, v41
    v_and_b32 v164, v41, v11
    v_and_b32 v165, v41, v12
    v_and_b32 v166, v41, v13
    v_and_b32 v167, v41, v14
    s_waitcnt vmcnt(9)
    v_mfma_f32_16x16x32_bf16 v[24:27], v[156:159], v[92:95], v[24:27]
    v_cvt_pk_bf16_f32 v42, v42, v42
    v_and_b32 v168, v42, v11
    v_and_b32 v169, v42, v12
    v_and_b32 v170, v42, v13
    v_and_b32 v171, v42, v14
    s_waitcnt vmcnt(8)
    v_mfma_f32_16x16x32_bf16 v[24:27], v[160:163], v[96:99], v[24:27]
    v_cvt_pk_bf16_f32 v43, v43, v43
    v_and_b32 v172, v43, v11
    v_and_b32 v173, v43, v12
    v_and_b32 v174, v43, v13
    v_and_b32 v175, v43, v14
    s_waitcnt vmcnt(7)
    v_mfma_f32_16x16x32_bf16 v[24:27], v[164:167], v[100:103], v[24:27]
    v_cvt_pk_bf16_f32 v44, v44, v44
    v_and_b32 v176, v44, v11
    v_and_b32 v177, v44, v12
    v_and_b32 v178, v44, v13
    v_and_b32 v179, v44, v14
    v_cvt_pk_bf16_f32 v45, v45, v45
    v_and_b32 v180, v45, v11
    v_and_b32 v181, v45, v12
    v_and_b32 v182, v45, v13
    v_and_b32 v183, v45, v14
    v_cvt_pk_bf16_f32 v46, v46, v46
    v_and_b32 v184, v46, v11
    v_and_b32 v185, v46, v12
    v_and_b32 v186, v46, v13
    v_and_b32 v187, v46, v14
    v_cvt_pk_bf16_f32 v47, v47, v47
    v_and_b32 v188, v47, v11
    v_and_b32 v189, v47, v12
    v_and_b32 v190, v47, v13
    v_and_b32 v191, v47, v14
    s_waitcnt vmcnt(6)
    v_mfma_f32_16x16x32_bf16 v[24:27], v[168:171], v[104:107], v[24:27]
    s_waitcnt vmcnt(5)
    v_mfma_f32_16x16x32_bf16 v[24:27], v[172:175], v[108:111], v[24:27]
    s_waitcnt vmcnt(4)
    v_mfma_f32_16x16x32_bf16 v[24:27], v[176:179], v[112:115], v[24:27]
    s_waitcnt vmcnt(3)
    v_mfma_f32_16x16x32_bf16 v[24:27], v[180:183], v[116:119], v[24:27]
    s_waitcnt vmcnt(2)
    v_mfma_f32_16x16x32_bf16 v[24:27], v[184:187], v[120:123], v[24:27]
    s_waitcnt vmcnt(1)
    v_mfma_f32_16x16x32_bf16 v[24:27], v[188:191], v[124:127], v[24:27]
    s_nop 7
    v_pk_mul_f32 v[24:25], v[24:25], v[60:61] op_sel_hi:[1,0]
    v_pk_mul_f32 v[26:27], v[26:27], v[60:61] op_sel_hi:[1,0]
    ds_write_b128 v57, v[24:27] offset:11584
    s_mov_b64 exec, 1
    ds_add_rtn_u32 v48, v15, v192 offset:19028
    s_waitcnt lgkmcnt(0)
    v_cmp_eq_u32 vcc, 3, v48
    s_mov_b64 exec, -1
    s_cbranch_vccz L_kv_tail
    ds_read_b128 v[32:35], v56 offset:11584
    ds_read_b128 v[36:39], v56 offset:12608
    ds_read_b128 v[44:47], v56 offset:13632
    ds_read_b128 v[48:51], v56 offset:14656
    s_waitcnt lgkmcnt(2)
    v_pk_add_f32 v[32:33], v[32:33], v[36:37]
    v_pk_add_f32 v[34:35], v[34:35], v[38:39]
    s_waitcnt lgkmcnt(0)
    v_pk_add_f32 v[44:45], v[44:45], v[48:49]
    v_pk_add_f32 v[46:47], v[46:47], v[50:51]
    v_pk_add_f32 v[32:33], v[32:33], v[44:45]
    v_pk_add_f32 v[34:35], v[34:35], v[46:47]
    v_bfi_b32 v32, v193, s96, v32
    v_bfi_b32 v33, v193, s97, v33
    v_bfi_b32 v34, v193, s98, v34
    v_bfi_b32 v35, v193, s99, v35
    s_cbranch_scc1 L_op_loc
    buffer_store_dwordx4 v[32:35], v56, s[44:47], s59 offen sc1
    s_branch L_op_done
L_op_loc:
    buffer_store_dwordx4 v[32:35], v56, s[44:47], s59 offen
L_op_done:
    s_mov_b64 exec, 1
    ds_add_u32 v15, v192 offset:19028
    s_mov_b64 exec, -1
L_kv_tail:
    s_cmp_lt_u32 s5, 18
    s_cbranch_scc1 L_kv_ffn
    s_cmp_lt_u32 s5, 27
    s_cbranch_scc0 L_end
    v_bfe_u32 v49, v0, 2, 2
    v_add_u32 v48, v54, v49
    v_lshlrev_b32 v48, 7, v48
    v_and_b32 v49, 3, v0
    v_lshl_add_u32 v48, v49, 5, v48
    v_bfe_u32 v49, v0, 4, 1
    v_lshl_add_u32 v48, v49, 4, v48
    s_lshl_b32 s60, s4, 5
    s_lshl_b32 s61, s3, 2
    s_add_u32 s60, s60, s61
    s_lshl_b32 s61, s60, 7
    s_add_u32 s61, s61, 299008
    s_lshl_b32 s60, s60, 10
    s_add_u32 s58, s60, 331776
    s_add_u32 s59, s58, 16384
    v_and_b32 v55, 15, v0
    v_lshlrev_b32 v55, 4, v55
    v_lshl_add_u32 v55, v49, 3, v55
    v_lshl_add_u32 v55, v54, 4, v55
    s_mul_i32 s60, s3, 1168
    v_add_u32 v55, s60, v55
    v_lshlrev_b32 v54, 2, v54
Lsp_19:
    ds_read_b32 v49, v15 offset:19040
    s_waitcnt lgkmcnt(0)
    v_cmp_gt_u32 vcc, 3, v49
    s_cbranch_vccnz Lsp_19
    s_mov_b32 s62, 400000
Lpo_20:
    s_sub_u32 s62, s62, 1
    s_cbranch_scc1 Lpd_21
    buffer_load_dwordx4 v[40:43], v48, s[44:47], s61 offen sc1
    s_waitcnt vmcnt(0)
    v_xor_b32 v40, s96, v40
    v_xor_b32 v41, s97, v41
    v_xor_b32 v42, s98, v42
    v_xor_b32 v43, s99, v43
    v_or3_b32 v49, v40, v41, v42
    v_or_b32 v49, v49, v43
    v_and_b32 v49, 0xff, v49
    v_cmp_ne_u32 vcc, 0, v49
    s_cbranch_vccnz Lpo_20
Lpd_21:
    v_mov_b32 v52, v40
    s_nop 1
    v_max_f32_dpp v52, v52, v52 row_ror:1 row_mask:0xf bank_mask:0xf
    s_nop 1
    v_max_f32_dpp v52, v52, v52 row_ror:2 row_mask:0xf bank_mask:0xf
    s_nop 1
    v_max_f32_dpp v52, v52, v52 row_ror:4 row_mask:0xf bank_mask:0xf
    s_nop 1
    v_max_f32_dpp v52, v52, v52 row_ror:8 row_mask:0xf bank_mask:0xf
    v_sub_f32 v52, v40, v52
    v_mul_f32 v52, s50, v52
    v_exp_f32 v52, v52
    s_nop 0
    v_mul_f32 v53, v52, v41
    s_nop 1
    v_add_f32_dpp v53, v53, v53 row_ror:1 row_mask:0xf bank_mask:0xf
    s_nop 1
    v_add_f32_dpp v53, v53, v53 row_ror:2 row_mask:0xf bank_mask:0xf
    s_nop 1
    v_add_f32_dpp v53, v53, v53 row_ror:4 row_mask:0xf bank_mask:0xf
    s_nop 1
    v_add_f32_dpp v53, v53, v53 row_ror:8 row_mask:0xf bank_mask:0xf
    v_rcp_f32 v53, v53
    s_nop 0
    v_mul_f32 v52, v52, v53
    ds_bpermute_b32 v16, v54, v52 offset:0
    ds_bpermute_b32 v18, v54, v52 offset:16
    ds_bpermute_b32 v20, v54, v52 offset:32
    ds_bpermute_b32 v22, v54, v52 offset:48
    ds_bpermute_b32 v24, v54, v52 offset:128
    ds_bpermute_b32 v26, v54, v52 offset:144
    ds_bpermute_b32 v28, v54, v52 offset:160
    ds_bpermute_b32 v30, v54, v52 offset:176
    s_mov_b32 s62, 400000
Lpo_23:
    s_sub_u32 s62, s62, 1
    s_cbranch_scc1 Lpd_24
    buffer_load_dwordx4 v[64:67], v56, s[44:47], s58 offen offset:0 sc1
    buffer_load_dwordx4 v[68:71], v56, s[44:47], s58 offen offset:1024 sc1
    buffer_load_dwordx4 v[72:75], v56, s[44:47], s58 offen offset:2048 sc1
    buffer_load_dwordx4 v[76:79], v56, s[44:47], s58 offen offset:3072 sc1
    buffer_load_dwordx4 v[80:83], v56, s[44:47], s59 offen offset:0 sc1
    buffer_load_dwordx4 v[84:87], v56, s[44:47], s59 offen offset:1024 sc1
    buffer_load_dwordx4 v[88:91], v56, s[44:47], s59 offen offset:2048 sc1
    buffer_load_dwordx4 v[92:95], v56, s[44:47], s59 offen offset:3072 sc1
    s_waitcnt vmcnt(7)
    v_xor_b32 v64, s96, v64
    v_xor_b32 v65, s97, v65
    v_xor_b32 v66, s98, v66
    v_xor_b32 v67, s99, v67
    v_or3_b32 v49, v64, v65, v66
    v_or_b32 v49, v49, v67
    s_waitcnt vmcnt(6)
    v_xor_b32 v68, s96, v68
    v_xor_b32 v69, s97, v69
    v_xor_b32 v70, s98, v70
    v_xor_b32 v71, s99, v71
    v_or3_b32 v49, v49, v68, v69
    v_or3_b32 v49, v49, v70, v71
    s_waitcnt vmcnt(5)
    v_xor_b32 v72, s96, v72
    v_xor_b32 v73, s97, v73
    v_xor_b32 v74, s98, v74
    v_xor_b32 v75, s99, v75
    v_or3_b32 v49, v49, v72, v73
    v_or3_b32 v49, v49, v74, v75
    s_waitcnt vmcnt(4)
    v_xor_b32 v76, s96, v76
    v_xor_b32 v77, s97, v77
    v_xor_b32 v78, s98, v78
    v_xor_b32 v79, s99, v79
    v_or3_b32 v49, v49, v76, v77
    v_or3_b32 v49, v49, v78, v79
    s_waitcnt vmcnt(3)
    v_xor_b32 v80, s96, v80
    v_xor_b32 v81, s97, v81
    v_xor_b32 v82, s98, v82
    v_xor_b32 v83, s99, v83
    v_or3_b32 v49, v49, v80, v81
    v_or3_b32 v49, v49, v82, v83
    s_waitcnt vmcnt(2)
    v_xor_b32 v84, s96, v84
    v_xor_b32 v85, s97, v85
    v_xor_b32 v86, s98, v86
    v_xor_b32 v87, s99, v87
    v_or3_b32 v49, v49, v84, v85
    v_or3_b32 v49, v49, v86, v87
    s_waitcnt vmcnt(1)
    v_xor_b32 v88, s96, v88
    v_xor_b32 v89, s97, v89
    v_xor_b32 v90, s98, v90
    v_xor_b32 v91, s99, v91
    v_or3_b32 v49, v49, v88, v89
    v_or3_b32 v49, v49, v90, v91
    s_waitcnt vmcnt(0)
    v_xor_b32 v92, s96, v92
    v_xor_b32 v93, s97, v93
    v_xor_b32 v94, s98, v94
    v_xor_b32 v95, s99, v95
    v_or3_b32 v49, v49, v92, v93
    v_or3_b32 v49, v49, v94, v95
    v_and_b32 v49, 0xff, v49
    v_cmp_ne_u32 vcc, 0, v49
    s_cbranch_vccnz Lpo_23
Lpd_24:
    s_waitcnt lgkmcnt(0)
    v_pk_mul_f32 v[32:33], v[64:65], v[16:17] op_sel_hi:[1,0]
    v_pk_mul_f32 v[34:35], v[66:67], v[16:17] op_sel_hi:[1,0]
    v_pk_fma_f32 v[32:33], v[68:69], v[18:19], v[32:33] op_sel_hi:[1,0,1]
    v_pk_fma_f32 v[34:35], v[70:71], v[18:19], v[34:35] op_sel_hi:[1,0,1]
    v_pk_fma_f32 v[32:33], v[72:73], v[20:21], v[32:33] op_sel_hi:[1,0,1]
    v_pk_fma_f32 v[34:35], v[74:75], v[20:21], v[34:35] op_sel_hi:[1,0,1]
    v_pk_fma_f32 v[32:33], v[76:77], v[22:23], v[32:33] op_sel_hi:[1,0,1]
    v_pk_fma_f32 v[34:35], v[78:79], v[22:23], v[34:35] op_sel_hi:[1,0,1]
    v_pk_mul_f32 v[36:37], v[80:81], v[24:25] op_sel_hi:[1,0]
    v_pk_mul_f32 v[38:39], v[82:83], v[24:25] op_sel_hi:[1,0]
    v_pk_fma_f32 v[36:37], v[84:85], v[26:27], v[36:37] op_sel_hi:[1,0,1]
    v_pk_fma_f32 v[38:39], v[86:87], v[26:27], v[38:39] op_sel_hi:[1,0,1]
    v_pk_fma_f32 v[36:37], v[88:89], v[28:29], v[36:37] op_sel_hi:[1,0,1]
    v_pk_fma_f32 v[38:39], v[90:91], v[28:29], v[38:39] op_sel_hi:[1,0,1]
    v_pk_fma_f32 v[36:37], v[92:93], v[30:31], v[36:37] op_sel_hi:[1,0,1]
    v_pk_fma_f32 v[38:39], v[94:95], v[30:31], v[38:39] op_sel_hi:[1,0,1]
    v_cvt_pk_bf16_f32 v32, v32, v33
    v_cvt_pk_bf16_f32 v33, v34, v35
    v_cvt_pk_bf16_f32 v36, v36, v37
    v_cvt_pk_bf16_f32 v37, v38, v39
    ds_write_b64 v55, v[32:33] offset:0
    ds_write_b64 v55, v[36:37] offset:512
    s_mov_b64 exec, 1
    ds_add_u32 v15, v192 offset:19008
    s_mov_b64 exec, -1
    s_endpgm
L_kv_ffn:
    v_lshlrev_b32 v13, 3, v0
    s_mul_i32 s60, s3, 1168
    v_add_u32 v13, s60, v13
    s_and_b32 s60, s5, 1
    s_lshl_b32 s60, s60, 3
    v_xor_b32 v13, s60, v13
    s_mul_i32 s61, s3, 2304
    s_add_u32 s58, s61, 271360
    s_add_u32 s59, s61, 280576
    s_mul_i32 s60, s4, 9216
    s_add_u32 s60, s60, s61
    s_add_u32 s60, s60, 1183744
    s_mov_b32 exec_lo, 0xffffffff
    s_mov_b32 exec_hi, 0xffff
Lsp_26:
    s_sleep 1
    ds_read_b32 v64, v15 offset:19040
    s_waitcnt lgkmcnt(0)
    v_cmp_gt_u32 vcc, 3, v64
    s_cbranch_vccnz Lsp_26
    s_mov_b32 s62, 400000
    s_branch Lp0_29
Lpo_27:
    s_sleep 8
    s_sub_u32 s62, s62, 1
    s_cbranch_scc1 Lpd_28
Lp0_29:
    buffer_load_dwordx4 v[40:43], v56, s[44:47], s58 offen offset:0 sc1
    buffer_load_dwordx4 v[44:47], v56, s[44:47], s58 offen offset:768 sc1
    buffer_load_dwordx4 v[48:51], v56, s[44:47], s58 offen offset:1536 sc1
    buffer_load_dwordx4 v[28:31], v56, s[44:47], s59 offen offset:0 sc1
    buffer_load_dwordx4 v[32:35], v56, s[44:47], s59 offen offset:768 sc1
    buffer_load_dwordx4 v[36:39], v56, s[44:47], s59 offen offset:1536 sc1
    s_waitcnt vmcnt(5)
    v_xor_b32 v40, s96, v40
    v_xor_b32 v41, s97, v41
    v_xor_b32 v42, s98, v42
    v_xor_b32 v43, s99, v43
    v_or3_b32 v64, v40, v41, v42
    v_or_b32 v64, v64, v43
    s_waitcnt vmcnt(4)
    v_xor_b32 v44, s96, v44
    v_xor_b32 v45, s97, v45
    v_xor_b32 v46, s98, v46
    v_xor_b32 v47, s99, v47
    v_or3_b32 v64, v64, v44, v45
    v_or3_b32 v64, v64, v46, v47
    s_waitcnt vmcnt(3)
    v_xor_b32 v48, s96, v48
    v_xor_b32 v49, s97, v49
    v_xor_b32 v50, s98, v50
    v_xor_b32 v51, s99, v51
    v_or3_b32 v64, v64, v48, v49
    v_or3_b32 v64, v64, v50, v51
    s_waitcnt vmcnt(2)
    v_xor_b32 v28, s96, v28
    v_xor_b32 v29, s97, v29
    v_xor_b32 v30, s98, v30
    v_xor_b32 v31, s99, v31
    v_or3_b32 v64, v64, v28, v29
    v_or3_b32 v64, v64, v30, v31
    s_waitcnt vmcnt(1)
    v_xor_b32 v32, s96, v32
    v_xor_b32 v33, s97, v33
    v_xor_b32 v34, s98, v34
    v_xor_b32 v35, s99, v35
    v_or3_b32 v64, v64, v32, v33
    v_or3_b32 v64, v64, v34, v35
    s_waitcnt vmcnt(0)
    v_xor_b32 v36, s96, v36
    v_xor_b32 v37, s97, v37
    v_xor_b32 v38, s98, v38
    v_xor_b32 v39, s99, v39
    v_or3_b32 v64, v64, v36, v37
    v_or3_b32 v64, v64, v38, v39
    v_and_b32 v64, 0xff, v64
    v_cmp_ne_u32 vcc, 0, v64
    s_cbranch_vccnz Lpo_27
Lpd_28:
    v_pk_add_f32 v[28:29], v[28:29], 1.0 op_sel_hi:[1,0]
    v_pk_add_f32 v[30:31], v[30:31], 1.0 op_sel_hi:[1,0]
    v_pk_add_f32 v[32:33], v[32:33], 1.0 op_sel_hi:[1,0]
    v_pk_add_f32 v[34:35], v[34:35], 1.0 op_sel_hi:[1,0]
    v_pk_add_f32 v[36:37], v[36:37], 1.0 op_sel_hi:[1,0]
    v_pk_add_f32 v[38:39], v[38:39], 1.0 op_sel_hi:[1,0]
    v_cvt_pk_bf16_f32 v64, v28, v29
    v_cvt_pk_bf16_f32 v65, v30, v31
    v_cvt_pk_bf16_f32 v66, v32, v33
    v_cvt_pk_bf16_f32 v67, v34, v35
    v_cvt_pk_bf16_f32 v68, v36, v37
    v_cvt_pk_bf16_f32 v69, v38, v39
    v_and_b32 v29, 0xffff0000, v64
    v_lshlrev_b32 v28, 16, v64
    v_and_b32 v31, 0xffff0000, v65
    v_lshlrev_b32 v30, 16, v65
    v_and_b32 v33, 0xffff0000, v66
    v_lshlrev_b32 v32, 16, v66
    v_and_b32 v35, 0xffff0000, v67
    v_lshlrev_b32 v34, 16, v67
    v_and_b32 v37, 0xffff0000, v68
    v_lshlrev_b32 v36, 16, v68
    v_and_b32 v39, 0xffff0000, v69
    v_lshlrev_b32 v38, 16, v69
Lsp_30:
    s_sleep 1
    ds_read_b32 v64, v15 offset:19040
    s_waitcnt lgkmcnt(0)
    v_cmp_gt_u32 vcc, 6, v64
    s_cbranch_vccnz Lsp_30
    s_mov_b32 s62, 400000
Lpo_31:
    s_sub_u32 s62, s62, 1
    s_cbranch_scc1 Lpd_32
    buffer_load_dwordx4 v[16:19], v56, s[44:47], s60 offen offset:0 sc1
    buffer_load_dwordx4 v[20:23], v56, s[44:47], s60 offen offset:768 sc1
    buffer_load_dwordx4 v[24:27], v56, s[44:47], s60 offen offset:1536 sc1
    s_waitcnt vmcnt(2)
    v_xor_b32 v16, s96, v16
    v_xor_b32 v17, s97, v17
    v_xor_b32 v18, s98, v18
    v_xor_b32 v19, s99, v19
    v_or3_b32 v64, v16, v17, v18
    v_or_b32 v64, v64, v19
    s_waitcnt vmcnt(1)
    v_xor_b32 v20, s96, v20
    v_xor_b32 v21, s97, v21
    v_xor_b32 v22, s98, v22
    v_xor_b32 v23, s99, v23
    v_or3_b32 v64, v64, v20, v21
    v_or3_b32 v64, v64, v22, v23
    s_waitcnt vmcnt(0)
    v_xor_b32 v24, s96, v24
    v_xor_b32 v25, s97, v25
    v_xor_b32 v26, s98, v26
    v_xor_b32 v27, s99, v27
    v_or3_b32 v64, v64, v24, v25
    v_or3_b32 v64, v64, v26, v27
    v_and_b32 v64, 0xff, v64
    v_cmp_ne_u32 vcc, 0, v64
    s_cbranch_vccnz Lpo_31
Lpd_32:
    v_pk_add_f32 v[64:65], v[16:17], v[18:19]
    v_pk_mul_f32 v[66:67], v[16:17], v[16:17]
    v_pk_fma_f32 v[66:67], v[18:19], v[18:19], v[66:67]
    v_pk_add_f32 v[64:65], v[64:65], v[20:21]
    v_pk_fma_f32 v[66:67], v[20:21], v[20:21], v[66:67]
    v_pk_add_f32 v[64:65], v[64:65], v[22:23]
    v_pk_fma_f32 v[66:67], v[22:23], v[22:23], v[66:67]
    v_pk_add_f32 v[64:65], v[64:65], v[24:25]
    v_pk_fma_f32 v[66:67], v[24:25], v[24:25], v[66:67]
    v_pk_add_f32 v[64:65], v[64:65], v[26:27]
    v_pk_fma_f32 v[66:67], v[26:27], v[26:27], v[66:67]
    v_add_f32 v64, v64, v65
    v_add_f32 v66, v66, v67
    s_nop 0
    v_add_f32_dpp v64, v64, v64 row_ror:1 row_mask:0xf bank_mask:0xf
    v_add_f32_dpp v66, v66, v66 row_ror:1 row_mask:0xf bank_mask:0xf
    s_nop 0
    v_add_f32_dpp v64, v64, v64 row_ror:2 row_mask:0xf bank_mask:0xf
    v_add_f32_dpp v66, v66, v66 row_ror:2 row_mask:0xf bank_mask:0xf
    s_nop 0
    v_add_f32_dpp v64, v64, v64 row_ror:4 row_mask:0xf bank_mask:0xf
    v_add_f32_dpp v66, v66, v66 row_ror:4 row_mask:0xf bank_mask:0xf
    s_nop 0
    v_add_f32_dpp v64, v64, v64 row_ror:8 row_mask:0xf bank_mask:0xf
    v_add_f32_dpp v66, v66, v66 row_ror:8 row_mask:0xf bank_mask:0xf
    v_readlane_b32 s52, v64, 0
    v_readlane_b32 s53, v64, 16
    v_readlane_b32 s54, v64, 32
    v_readlane_b32 s55, v66, 0
    v_readlane_b32 s56, v66, 16
    v_readlane_b32 s57, v66, 32
    v_mov_b32 v64, s52
    v_add_f32 v64, s53, v64
    v_mov_b32 v66, s55
    v_add_f32 v64, s54, v64
    v_add_f32 v66, s56, v66
    v_add_f32 v66, s57, v66
    v_mul_f32 v64, 0x3ae38e39, v64
    v_mul_f32 v66, 0x3ae38e39, v66
    v_fma_f32 v66, -v64, v64, v66
    v_max_f32 v66, 0, v66
    v_cvt_pk_bf16_f32 v65, v64, v66
    v_and_b32 v66, 0xffff0000, v65
    v_lshlrev_b32 v64, 16, v65
    v_add_f32 v66, 0x3727c5ac, v66
    v_cvt_pk_bf16_f32 v66, v66, v66
    v_pk_add_f32 v[16:17], v[16:17], v[64:65] op_sel_hi:[1,0] neg_lo:[0,1] neg_hi:[0,1]
    v_lshlrev_b32 v66, 16, v66
    v_pk_add_f32 v[18:19], v[18:19], v[64:65] op_sel_hi:[1,0] neg_lo:[0,1] neg_hi:[0,1]
    v_sqrt_f32 v66, v66
    v_pk_add_f32 v[20:21], v[20:21], v[64:65] op_sel_hi:[1,0] neg_lo:[0,1] neg_hi:[0,1]
    v_pk_add_f32 v[22:23], v[22:23], v[64:65] op_sel_hi:[1,0] neg_lo:[0,1] neg_hi:[0,1]
    v_pk_add_f32 v[24:25], v[24:25], v[64:65] op_sel_hi:[1,0] neg_lo:[0,1] neg_hi:[0,1]
    v_pk_add_f32 v[26:27], v[26:27], v[64:65] op_sel_hi:[1,0] neg_lo:[0,1] neg_hi:[0,1]
    v_cvt_pk_bf16_f32 v66, v66, v66
    v_lshlrev_b32 v66, 16, v66
    v_rcp_f32 v66, v66
    v_cvt_pk_bf16_f32 v68, v16, v17
    v_cvt_pk_bf16_f32 v69, v18, v19
    v_cvt_pk_bf16_f32 v70, v20, v21
    v_cvt_pk_bf16_f32 v71, v22, v23
    v_cvt_pk_bf16_f32 v72, v24, v25
    v_cvt_pk_bf16_f32 v73, v26, v27
    v_and_b32 v17, 0xffff0000, v68
    v_lshlrev_b32 v16, 16, v68
    v_and_b32 v19, 0xffff0000, v69
    v_lshlrev_b32 v18, 16, v69
    v_and_b32 v21, 0xffff0000, v70
    v_lshlrev_b32 v20, 16, v70
    v_and_b32 v23, 0xffff0000, v71
    v_lshlrev_b32 v22, 16, v71
    v_and_b32 v25, 0xffff0000, v72
    v_lshlrev_b32 v24, 16, v72
    v_and_b32 v27, 0xffff0000, v73
    v_lshlrev_b32 v26, 16, v73
    v_pk_mul_f32 v[16:17], v[16:17], v[66:67] op_sel_hi:[1,0]
    v_pk_mul_f32 v[18:19], v[18:19], v[66:67] op_sel_hi:[1,0]
    v_pk_mul_f32 v[20:21], v[20:21], v[66:67] op_sel_hi:[1,0]
    v_pk_mul_f32 v[22:23], v[22:23], v[66:67] op_sel_hi:[1,0]
    v_pk_mul_f32 v[24:25], v[24:25], v[66:67] op_sel_hi:[1,0]
    v_pk_mul_f32 v[26:27], v[26:27], v[66:67] op_sel_hi:[1,0]
    v_cvt_pk_bf16_f32 v68, v16, v17
    v_cvt_pk_bf16_f32 v69, v18, v19
    v_cvt_pk_bf16_f32 v70, v20, v21
    v_cvt_pk_bf16_f32 v71, v22, v23
    v_cvt_pk_bf16_f32 v72, v24, v25
    v_cvt_pk_bf16_f32 v73, v26, v27
    v_and_b32 v17, 0xffff0000, v68
    v_lshlrev_b32 v16, 16, v68
    v_and_b32 v19, 0xffff0000, v69
    v_lshlrev_b32 v18, 16, v69
    v_and_b32 v21, 0xffff0000, v70
    v_lshlrev_b32 v20, 16, v70
    v_and_b32 v23, 0xffff0000, v71
    v_lshlrev_b32 v22, 16, v71
    v_and_b32 v25, 0xffff0000, v72
    v_lshlrev_b32 v24, 16, v72
    v_and_b32 v27, 0xffff0000, v73
    v_lshlrev_b32 v26, 16, v73
    v_pk_mul_f32 v[16:17], v[16:17], v[28:29]
    v_pk_mul_f32 v[18:19], v[18:19], v[30:31]
    v_pk_mul_f32 v[20:21], v[20:21], v[32:33]
    v_pk_mul_f32 v[22:23], v[22:23], v[34:35]
    v_pk_mul_f32 v[24:25], v[24:25], v[36:37]
    v_pk_mul_f32 v[26:27], v[26:27], v[38:39]
    v_cvt_pk_bf16_f32 v64, v16, v17
    v_cvt_pk_bf16_f32 v65, v18, v19
    v_cvt_pk_bf16_f32 v66, v20, v21
    v_cvt_pk_bf16_f32 v67, v22, v23
    v_cvt_pk_bf16_f32 v68, v24, v25
    v_cvt_pk_bf16_f32 v69, v26, v27
    v_and_b32 v17, 0xffff0000, v64
    v_lshlrev_b32 v16, 16, v64
    v_and_b32 v19, 0xffff0000, v65
    v_lshlrev_b32 v18, 16, v65
    v_and_b32 v21, 0xffff0000, v66
    v_lshlrev_b32 v20, 16, v66
    v_and_b32 v23, 0xffff0000, v67
    v_lshlrev_b32 v22, 16, v67
    v_and_b32 v25, 0xffff0000, v68
    v_lshlrev_b32 v24, 16, v68
    v_and_b32 v27, 0xffff0000, v69
    v_lshlrev_b32 v26, 16, v69
    v_pk_add_f32 v[16:17], v[16:17], v[40:41]
    v_pk_add_f32 v[18:19], v[18:19], v[42:43]
    v_pk_add_f32 v[20:21], v[20:21], v[44:45]
    v_pk_add_f32 v[22:23], v[22:23], v[46:47]
    v_pk_add_f32 v[24:25], v[24:25], v[48:49]
    v_pk_add_f32 v[26:27], v[26:27], v[50:51]
    v_cvt_pk_bf16_f32 v64, v16, v17
    v_cvt_pk_bf16_f32 v65, v18, v19
    ds_write_b64 v13, v[64:65] offset:0
    v_cvt_pk_bf16_f32 v66, v20, v21
    v_cvt_pk_bf16_f32 v67, v22, v23
    ds_write_b64 v13, v[66:67] offset:384
    v_cvt_pk_bf16_f32 v68, v24, v25
    v_cvt_pk_bf16_f32 v69, v26, v27
    ds_write_b64 v13, v[68:69] offset:768
    s_mov_b64 exec, 1
    ds_add_u32 v15, v192 offset:19008
    s_mov_b64 exec, -1
    s_endpgm
L_w_q1:
    s_waitcnt vmcnt(7)
    buffer_load_dwordx4 v[112:115], v1, s[36:39], s52 offen offset:0 nt
    s_waitcnt vmcnt(7)
    buffer_load_dwordx4 v[144:147], v1, s[36:39], s52 offen offset:128 nt
    s_add_u32 s52, s52, s56
    s_waitcnt vmcnt(7)
    buffer_load_dwordx4 v[116:119], v1, s[36:39], s52 offen offset:0 nt
    s_waitcnt vmcnt(7)
    buffer_load_dwordx4 v[148:151], v1, s[36:39], s52 offen offset:128 nt
    s_add_u32 s52, s52, s56
    s_waitcnt vmcnt(7)
    buffer_load_dwordx4 v[120:123], v1, s[36:39], s52 offen offset:0 nt
    s_waitcnt vmcnt(7)
    buffer_load_dwordx4 v[152:155], v1, s[36:39], s52 offen offset:128 nt
    s_add_u32 s52, s52, s56
    s_waitcnt vmcnt(7)
    buffer_load_dwordx4 v[124:127], v1, s[36:39], s52 offen offset:0 nt
    s_waitcnt vmcnt(7)
    buffer_load_dwordx4 v[156:159], v1, s[36:39], s52 offen offset:128 nt
    s_mov_b64 exec, 1
    ds_add_u32 v15, v14 offset:19056
    s_mov_b64 exec, -1
L_w_early:
    v_mov_b32 v11, 0xff
    v_and_b32 v5, 3, v0
    v_mul_u32_u24 v5, 400, v5
    v_and_b32 v6, 4, v0
    v_lshl_add_u32 v5, v6, 4, v5
    v_and_b32 v6, 48, v0
    s_mul_i32 s54, s7, 128
    s_add_u32 s54, s54, 19648
    v_add3_u32 v5, v5, v6, s54
    v_mov_b32 v6, 18496
    v_and_b32 v7, 8, v0
    v_cmp_eq_u32 vcc, 0, v7
    s_nop 1
    v_cndmask_b32 v2, v6, v5, vcc
    v_cndmask_b32 v3, v5, v6, vcc
    v_bfe_u32 v5, v0, 3, 1
    v_mul_u32_u24 v5, 1152, v5
    v_lshrrev_b32 v6, 5, v0
    v_mul_u32_u24 v6, 144, v6
    v_add_u32 v5, v5, v6
    v_and_b32 v6, 7, v0
    v_lshl_add_u32 v5, v6, 4, v5
    s_mul_i32 s54, s7, 2304
    v_add_u32 v4, s54, v5
    s_mov_b32 s60, 0x05040100
    s_mov_b32 s61, 0x07060302
    s_mov_b32 s44, s34
    s_mov_b32 s45, s35
    s_mov_b32 s46, 8388608
    s_mov_b32 s47, 0x20000
    s_lshl_b32 s54, s7, 7
    v_add_u32 v12, s54, v12
    v_lshlrev_b32 v13, 4, v0
    s_lshl_b32 s58, s58, 4
    s_add_u32 s58, s58, 8192
    s_waitcnt lgkmcnt(0)
    s_add_u32 s100, s100, 0x01010101
    s_bfe_u32 s96, s100, 0x80000
    s_bfe_u32 s97, s100, 0x80008
    s_bfe_u32 s98, s100, 0x80010
    s_bfe_u32 s99, s100, 0x80018
    s_waitcnt vmcnt(8)
    v_lshlrev_b32 v56, 16, v56
    v_lshlrev_b32 v57, 16, v57
    v_lshlrev_b32 v58, 16, v58
    v_lshlrev_b32 v59, 16, v59
    s_cmp_lt_u32 s2, 96
    s_cbranch_scc1 L_w_q
    v_mul_f32 v16, 0xbfb8aa3b, v56
    v_mul_f32 v17, 0xbfb8aa3b, v57
    v_mul_f32 v18, 0xbfb8aa3b, v58
    v_mul_f32 v19, 0xbfb8aa3b, v59
    v_min_f32 v16, 0x42fc0000, v16
    v_min_f32 v17, 0x42fc0000, v17
    v_min_f32 v18, 0x42fc0000, v18
    v_min_f32 v19, 0x42fc0000, v19
    v_exp_f32 v16, v16
    v_exp_f32 v17, v17
    v_exp_f32 v18, v18
    v_exp_f32 v19, v19
    v_add_f32 v16, 1.0, v16
    v_add_f32 v17, 1.0, v17
    v_add_f32 v18, 1.0, v18
    v_add_f32 v19, 1.0, v19
    v_rcp_f32 v20, v16
    v_rcp_f32 v21, v17
    v_rcp_f32 v22, v18
    v_rcp_f32 v23, v19
    v_pk_mul_f32 v[24:25], v[56:57], v[20:21]
    v_pk_fma_f32 v[56:57], v[24:25], v[16:17], v[56:57] neg_lo:[1,0,0] neg_hi:[1,0,0]
    v_pk_fma_f32 v[56:57], v[56:57], v[20:21], v[24:25]
    v_pk_mul_f32 v[24:25], v[58:59], v[22:23]
    v_pk_fma_f32 v[58:59], v[24:25], v[18:19], v[58:59] neg_lo:[1,0,0] neg_hi:[1,0,0]
    v_pk_fma_f32 v[58:59], v[58:59], v[22:23], v[24:25]
    v_cvt_pk_bf16_f32 v60, v56, v57
    v_cvt_pk_bf16_f32 v61, v58, v59
    ds_write_b16 v12, v60 offset:19648
    ds_write_b16_d16_hi v12, v60 offset:20048
    ds_write_b16 v12, v61 offset:20448
    ds_write_b16_d16_hi v12, v61 offset:20848
    s_waitcnt vmcnt(0)
    v_perm_b32 v64, v100, v96, s60
    v_perm_b32 v65, v108, v104, s60
    v_perm_b32 v66, v116, v112, s60
    v_perm_b32 v67, v124, v120, s60
    v_perm_b32 v68, v100, v96, s61
    v_perm_b32 v69, v108, v104, s61
    v_perm_b32 v70, v116, v112, s61
    v_perm_b32 v71, v124, v120, s61
    v_perm_b32 v72, v101, v97, s60
    v_perm_b32 v73, v109, v105, s60
    v_perm_b32 v74, v117, v113, s60
    v_perm_b32 v75, v125, v121, s60
    v_perm_b32 v76, v101, v97, s61
    v_perm_b32 v77, v109, v105, s61
    v_perm_b32 v78, v117, v113, s61
    v_perm_b32 v79, v125, v121, s61
    v_perm_b32 v80, v102, v98, s60
    v_perm_b32 v81, v110, v106, s60
    v_perm_b32 v82, v118, v114, s60
    v_perm_b32 v83, v126, v122, s60
    v_perm_b32 v84, v102, v98, s61
    v_perm_b32 v85, v110, v106, s61
    v_perm_b32 v86, v118, v114, s61
    v_perm_b32 v87, v126, v122, s61
    v_perm_b32 v88, v103, v99, s60
    v_perm_b32 v89, v111, v107, s60
    v_perm_b32 v90, v119, v115, s60
    v_perm_b32 v91, v127, v123, s60
    v_perm_b32 v92, v103, v99, s61
    v_perm_b32 v93, v111, v107, s61
    v_perm_b32 v94, v119, v115, s61
    v_perm_b32 v95, v127, v123, s61
    s_branch L_w_emm
L_w_q:
Lsp_34:
    s_sleep 1
    ds_read_b32 v5, v15 offset:19044
    s_waitcnt lgkmcnt(0)
    v_cmp_gt_u32 vcc, 1, v5
    s_cbranch_vccnz Lsp_34
    ds_read_b128 v[16:19], v15 offset:19104
    ds_read_b128 v[20:23], v15 offset:19120
    s_waitcnt lgkmcnt(0)
    v_pk_add_f32 v[56:57], v[56:57], v[16:17] neg_lo:[0,1] neg_hi:[0,1]
    v_pk_add_f32 v[58:59], v[58:59], v[18:19] neg_lo:[0,1] neg_hi:[0,1]
    v_cvt_pk_bf16_f32 v60, v56, v57
    v_cvt_pk_bf16_f32 v61, v58, v59
    v_and_b32 v57, 0xffff0000, v60
    v_lshlrev_b32 v56, 16, v60
    v_and_b32 v59, 0xffff0000, v61
    v_lshlrev_b32 v58, 16, v61
    v_pk_mul_f32 v[56:57], v[56:57], v[20:21]
    v_pk_mul_f32 v[58:59], v[58:59], v[22:23]
    v_cvt_pk_bf16_f32 v60, v56, v57
    v_cvt_pk_bf16_f32 v61, v58, v59
    v_and_b32 v57, 0xffff0000, v60
    v_lshlrev_b32 v56, 16, v60
    v_and_b32 v59, 0xffff0000, v61
    v_lshlrev_b32 v58, 16, v61
    s_lshl_b32 s52, s4, 7
    s_add_u32 s52, s52, s58
    s_add_u32 s40, s34, s52
    s_addc_u32 s41, s35, 0
    s_add_u32 s53, s58, 9216
    s_add_u32 s54, s58, 18432
    s_add_u32 s55, s58, 27648
    s_add_u32 s56, s58, 36864
    s_add_u32 s57, s58, 46080
    s_waitcnt vmcnt(2)
    buffer_load_dwordx4 v[16:19], v13, s[44:47], s58 offen sc1
    buffer_load_dwordx4 v[20:23], v13, s[44:47], s54 offen sc1
    buffer_load_dwordx4 v[24:27], v13, s[44:47], s56 offen sc1
    buffer_load_dwordx4 v[28:31], v13, s[44:47], s53 offen sc1
    buffer_load_dwordx4 v[32:35], v13, s[44:47], s55 offen sc1
    buffer_load_dwordx4 v[36:39], v13, s[44:47], s57 offen sc1
    s_waitcnt vmcnt(6)
    v_perm_b32 v64, v100, v96, s60
    v_perm_b32 v65, v108, v104, s60
    v_perm_b32 v66, v116, v112, s60
    v_perm_b32 v67, v124, v120, s60
    v_perm_b32 v68, v100, v96, s61
    v_perm_b32 v69, v108, v104, s61
    v_perm_b32 v70, v116, v112, s61
    v_perm_b32 v71, v124, v120, s61
    v_perm_b32 v72, v101, v97, s60
    v_perm_b32 v73, v109, v105, s60
    v_perm_b32 v74, v117, v113, s60
    v_perm_b32 v75, v125, v121, s60
    v_perm_b32 v76, v101, v97, s61
    v_perm_b32 v77, v109, v105, s61
    v_perm_b32 v78, v117, v113, s61
    v_perm_b32 v79, v125, v121, s61
    v_perm_b32 v80, v102, v98, s60
    v_perm_b32 v81, v110, v106, s60
    v_perm_b32 v82, v118, v114, s60
    v_perm_b32 v83, v126, v122, s60
    v_perm_b32 v84, v102, v98, s61
    v_perm_b32 v85, v110, v106, s61
    v_perm_b32 v86, v118, v114, s61
    v_perm_b32 v87, v126, v122, s61
    v_perm_b32 v88, v103, v99, s60
    v_perm_b32 v89, v111, v107, s60
    v_perm_b32 v90, v119, v115, s60
    v_perm_b32 v91, v127, v123, s60
    v_perm_b32 v92, v103, v99, s61
    v_perm_b32 v93, v111, v107, s61
    v_perm_b32 v94, v119, v115, s61
    v_perm_b32 v95, v127, v123, s61
    v_perm_b32 v96, v132, v128, s60
    v_perm_b32 v97, v140, v136, s60
    v_perm_b32 v98, v148, v144, s60
    v_perm_b32 v99, v156, v152, s60
    v_perm_b32 v100, v132, v128, s61
    v_perm_b32 v101, v140, v136, s61
    v_perm_b32 v102, v148, v144, s61
    v_perm_b32 v103, v156, v152, s61
    v_perm_b32 v104, v133, v129, s60
    v_perm_b32 v105, v141, v137, s60
    v_perm_b32 v106, v149, v145, s60
    v_perm_b32 v107, v157, v153, s60
    v_perm_b32 v108, v133, v129, s61
    v_perm_b32 v109, v141, v137, s61
    v_perm_b32 v110, v149, v145, s61
    v_perm_b32 v111, v157, v153, s61
    v_perm_b32 v112, v134, v130, s60
    v_perm_b32 v113, v142, v138, s60
    v_perm_b32 v114, v150, v146, s60
    v_perm_b32 v115, v158, v154, s60
    v_perm_b32 v116, v134, v130, s61
    v_perm_b32 v117, v142, v138, s61
    v_perm_b32 v118, v150, v146, s61
    v_perm_b32 v119, v158, v154, s61
    v_perm_b32 v120, v135, v131, s60
    v_perm_b32 v121, v143, v139, s60
    v_perm_b32 v122, v151, v147, s60
    v_perm_b32 v123, v159, v155, s60
    v_perm_b32 v124, v135, v131, s61
    v_perm_b32 v125, v143, v139, s61
    v_perm_b32 v126, v151, v147, s61
    v_perm_b32 v127, v159, v155, s61
    s_mov_b32 s62, 400000
    s_branch Lp0_37
Lpo_35:
    s_sub_u32 s62, s62, 1
    s_cbranch_scc1 Lpd_36
    buffer_load_dwordx4 v[16:19], v13, s[44:47], s58 offen sc1
    buffer_load_dwordx4 v[20:23], v13, s[44:47], s54 offen sc1
    buffer_load_dwordx4 v[24:27], v13, s[44:47], s56 offen sc1
    buffer_load_dwordx4 v[28:31], v13, s[44:47], s53 offen sc1
    buffer_load_dwordx4 v[32:35], v13, s[44:47], s55 offen sc1
    buffer_load_dwordx4 v[36:39], v13, s[44:47], s57 offen sc1
Lp0_37:
    s_waitcnt vmcnt(5)
    v_xor_b32 v16, s96, v16
    v_xor_b32 v17, s97, v17
    v_xor_b32 v18, s98, v18
    v_xor_b32 v19, s99, v19
    v_or3_b32 v5, v16, v17, v18
    v_or_b32 v5, v5, v19
    s_waitcnt vmcnt(4)
    v_xor_b32 v20, s96, v20
    v_xor_b32 v21, s97, v21
    v_xor_b32 v22, s98, v22
    v_xor_b32 v23, s99, v23
    v_or3_b32 v5, v5, v20, v21
    v_or3_b32 v5, v5, v22, v23
    s_waitcnt vmcnt(3)
    v_xor_b32 v24, s96, v24
    v_xor_b32 v25, s97, v25
    v_xor_b32 v26, s98, v26
    v_xor_b32 v27, s99, v27
    v_or3_b32 v5, v5, v24, v25
    v_or3_b32 v5, v5, v26, v27
    s_waitcnt vmcnt(2)
    v_xor_b32 v28, s96, v28
    v_xor_b32 v29, s97, v29
    v_xor_b32 v30, s98, v30
    v_xor_b32 v31, s99, v31
    v_or3_b32 v5, v5, v28, v29
    v_or3_b32 v5, v5, v30, v31
    s_waitcnt vmcnt(1)
    v_xor_b32 v32, s96, v32
    v_xor_b32 v33, s97, v33
    v_xor_b32 v34, s98, v34
    v_xor_b32 v35, s99, v35
    v_or3_b32 v5, v5, v32, v33
    v_or3_b32 v5, v5, v34, v35
    s_waitcnt vmcnt(0)
    v_xor_b32 v36, s96, v36
    v_xor_b32 v37, s97, v37
    v_xor_b32 v38, s98, v38
    v_xor_b32 v39, s99, v39
    v_or3_b32 v5, v5, v36, v37
    v_or3_b32 v5, v5, v38, v39
    v_and_b32 v5, 0xff, v5
    v_cmp_ne_u32 vcc, 0, v5
    s_cbranch_vccnz Lpo_35
Lpd_36:
    s_mov_b64 exec, 1
    ds_add_u32 v15, v14 offset:19056
    s_mov_b64 exec, -1
    v_pk_add_f32 v[28:29], v[28:29], v[32:33]
    v_pk_add_f32 v[30:31], v[30:31], v[34:35]
    v_pk_add_f32 v[28:29], v[28:29], v[36:37]
    v_pk_add_f32 v[30:31], v[30:31], v[38:39]
    v_pk_add_f32 v[16:17], v[16:17], v[20:21]
    v_pk_add_f32 v[18:19], v[18:19], v[22:23]
    v_pk_add_f32 v[16:17], v[16:17], v[24:25]
    v_pk_add_f32 v[18:19], v[18:19], v[26:27]
    v_cvt_pk_bf16_f32 v60, v28, v29
    v_cvt_pk_bf16_f32 v61, v30, v31
    v_cvt_pk_bf16_f32 v62, v16, v17
    v_cvt_pk_bf16_f32 v63, v18, v19
    v_and_b32 v29, 0xffff0000, v60
    v_lshlrev_b32 v28, 16, v60
    v_and_b32 v31, 0xffff0000, v61
    v_lshlrev_b32 v30, 16, v61
    v_pk_add_f32 v[28:29], v[28:29], 1.0 op_sel_hi:[1,0]
    v_pk_add_f32 v[30:31], v[30:31], 1.0 op_sel_hi:[1,0]
    v_and_b32 v17, 0xffff0000, v62
    v_lshlrev_b32 v16, 16, v62
    v_and_b32 v19, 0xffff0000, v63
    v_lshlrev_b32 v18, 16, v63
    v_cvt_pk_bf16_f32 v60, v28, v29
    v_cvt_pk_bf16_f32 v61, v30, v31
    v_and_b32 v29, 0xffff0000, v60
    v_lshlrev_b32 v28, 16, v60
    v_and_b32 v31, 0xffff0000, v61
    v_lshlrev_b32 v30, 16, v61
    v_pk_mul_f32 v[56:57], v[56:57], v[28:29]
    v_pk_mul_f32 v[58:59], v[58:59], v[30:31]
    v_cvt_pk_bf16_f32 v60, v56, v57
    v_cvt_pk_bf16_f32 v61, v58, v59
    v_and_b32 v57, 0xffff0000, v60
    v_lshlrev_b32 v56, 16, v60
    v_and_b32 v59, 0xffff0000, v61
    v_lshlrev_b32 v58, 16, v61
    v_pk_add_f32 v[56:57], v[56:57], v[16:17]
    v_pk_add_f32 v[58:59], v[58:59], v[18:19]
    v_cvt_pk_bf16_f32 v60, v56, v57
    v_cvt_pk_bf16_f32 v61, v58, v59
    ds_write_b16 v12, v60 offset:19648
    ds_write_b16_d16_hi v12, v60 offset:20048
    ds_write_b16 v12, v61 offset:20448
    ds_write_b16_d16_hi v12, v61 offset:20848
    ds_read_b128 v[16:19], v2
    ds_read_b128 v[20:23], v3
    s_waitcnt lgkmcnt(1)
    v_mfma_f32_16x16x32_bf16 v[24:27], v[16:19], v[64:67], 0
    v_mfma_f32_16x16x32_bf16 v[28:31], v[16:19], v[72:75], 0
    v_mfma_f32_16x16x32_bf16 v[32:35], v[16:19], v[80:83], 0
    v_mfma_f32_16x16x32_bf16 v[36:39], v[16:19], v[88:91], 0
    v_mfma_f32_16x16x32_bf16 v[40:43], v[16:19], v[96:99], 0
    v_mfma_f32_16x16x32_bf16 v[44:47], v[16:19], v[104:107], 0
    v_mfma_f32_16x16x32_bf16 v[48:51], v[16:19], v[112:115], 0
    v_mfma_f32_16x16x32_bf16 v[52:55], v[16:19], v[120:123], 0
    s_waitcnt lgkmcnt(0)
    v_mfma_f32_16x16x32_bf16 v[24:27], v[20:23], v[68:71], v[24:27]
    v_mfma_f32_16x16x32_bf16 v[28:31], v[20:23], v[76:79], v[28:31]
    v_mfma_f32_16x16x32_bf16 v[32:35], v[20:23], v[84:87], v[32:35]
    v_mfma_f32_16x16x32_bf16 v[36:39], v[20:23], v[92:95], v[36:39]
    v_mfma_f32_16x16x32_bf16 v[40:43], v[20:23], v[100:103], v[40:43]
    v_mfma_f32_16x16x32_bf16 v[44:47], v[20:23], v[108:111], v[44:47]
    v_mfma_f32_16x16x32_bf16 v[48:51], v[20:23], v[116:119], v[48:51]
    v_mfma_f32_16x16x32_bf16 v[52:55], v[20:23], v[124:127], v[52:55]
    s_mov_b32 exec_lo, 0xff0000ff
    s_mov_b32 exec_hi, 0xff0000ff
    ds_write_b128 v4, v[24:27] offset:21248
    ds_write_b128 v4, v[28:31] offset:21536
    ds_write_b128 v4, v[32:35] offset:21824
    ds_write_b128 v4, v[36:39] offset:22112
    ds_write_b128 v4, v[40:43] offset:28160
    ds_write_b128 v4, v[44:47] offset:28448
    ds_write_b128 v4, v[48:51] offset:28736
    ds_write_b128 v4, v[52:55] offset:29024
    s_mov_b64 exec, 1
    ds_add_u32 v15, v14 offset:19016
    s_mov_b64 exec, -1
    s_branch L_w_late
L_w_emm:
    ds_read_b128 v[16:19], v2 offset:0
    ds_read_b128 v[20:23], v3 offset:0
    s_waitcnt lgkmcnt(1)
    v_mfma_f32_16x16x32_bf16 v[40:43], v[16:19], v[64:67], 0
    v_mfma_f32_16x16x32_bf16 v[44:47], v[16:19], v[72:75], 0
    v_mfma_f32_16x16x32_bf16 v[48:51], v[16:19], v[80:83], 0
    v_mfma_f32_16x16x32_bf16 v[52:55], v[16:19], v[88:91], 0
    s_waitcnt lgkmcnt(0)
    v_mfma_f32_16x16x32_bf16 v[40:43], v[20:23], v[68:71], v[40:43]
    v_mfma_f32_16x16x32_bf16 v[44:47], v[20:23], v[76:79], v[44:47]
    v_mfma_f32_16x16x32_bf16 v[48:51], v[20:23], v[84:87], v[48:51]
    v_mfma_f32_16x16x32_bf16 v[52:55], v[20:23], v[92:95], v[52:55]
    s_mov_b32 exec_lo, 0xff0000ff
    s_mov_b32 exec_hi, 0xff0000ff
    s_nop 2
    ds_write_b128 v4, v[40:43] offset:21248
    ds_write_b128 v4, v[44:47] offset:21536
    ds_write_b128 v4, v[48:51] offset:21824
    ds_write_b128 v4, v[52:55] offset:22112
    s_mov_b64 exec, 1
    ds_add_u32 v15, v14 offset:19016
    s_mov_b64 exec, -1
    s_branch L_w_late
L_w_l0:
    v_bfe_u32 v5, v0, 3, 1
    v_mul_u32_u24 v5, 1152, v5
    v_lshrrev_b32 v6, 5, v0
    v_mul_u32_u24 v6, 144, v6
    v_add_u32 v5, v5, v6
    v_and_b32 v6, 7, v0
    v_lshl_add_u32 v5, v6, 4, v5
    s_mul_i32 s54, s7, 2304
    v_add_u32 v4, s54, v5
    s_mov_b32 s60, 0x05040100
    s_mov_b32 s61, 0x07060302
L_w_late:
    s_cmp_ge_u32 s2, 252
    s_cbranch_scc1 L_end
    v_and_b32 v5, 3, v0
    v_mul_u32_u24 v5, 1168, v5
    v_and_b32 v6, 4, v0
    v_lshl_add_u32 v5, v6, 4, v5
    v_and_b32 v6, 48, v0
    s_mul_i32 s54, s7, 384
    s_add_u32 s54, s54, 0
    v_add3_u32 v5, v5, v6, s54
    v_mov_b32 v6, 18496
    v_and_b32 v7, 8, v0
    v_cmp_eq_u32 vcc, 0, v7
    s_nop 1
    v_cndmask_b32 v2, v6, v5, vcc
    v_cndmask_b32 v3, v5, v6, vcc
    s_cmp_lt_u32 s2, 144
    s_cbranch_scc1 L_w_ffn
    s_sub_u32 s53, s5, 18
    s_mul_i32 s54, s4, 4608
    s_add_u32 s53, s53, s54
    s_sub_u32 s6, s2, 198
    s_cmp_lt_u32 s2, 216
    s_cselect_b32 s53, s53, s6
    s_movk_i32 s56, 6912
    s_cmovk_i32 s56, 1152
    s_movk_i32 s38, 576
    s_cmovk_i32 s38, 4096
    s_cselect_b64 s[36:37], s[16:17], s[28:29]
    s_cselect_b32 s59, s7, 0
    s_lshl_b32 s53, s53, 7
    s_mul_i32 s38, s56, s38
    s_mov_b32 s39, 0x20000
    s_mul_i32 s52, s7, 192
    s_mul_i32 s52, s52, s56
    s_add_u32 s52, s52, s53
    s_mul_i32 s57, s56, 57
    s_cmp_eq_u32 s59, 2
    s_cselect_b32 s54, 0, 256
    v_add_u32 v8, s54, v2
    v_add_u32 v9, s54, v3
    v_and_b32 v5, 8, v0
    v_lshrrev_b32 v6, 4, v0
    v_lshlrev_b32 v6, 1, v6
    v_add_u32 v5, v5, v6
    v_mul_u32_u24 v1, s56, v5
    v_and_b32 v5, 7, v0
    v_lshlrev_b32 v5, 2, v5
    v_add_lshl_u32 v1, v1, v5, 2
    s_mov_b32 s48, s26
    s_mov_b32 s49, s27
    s_mov_b32 s50, 4608
    s_mov_b32 s51, 0x20000
    s_mul_i32 s54, s7, 384
    v_lshlrev_b32 v12, 1, v0
    v_add_u32 v12, s54, v12
Lsp_38:
    s_sleep 2
    ds_read_b32 v5, v15 offset:19036
    s_waitcnt lgkmcnt(0)
    v_cmp_gt_u32 vcc, 4, v5
    s_cbranch_vccnz Lsp_38
    s_cmp_lt_u32 s2, 225
    s_cselect_b64 vcc, 0, -1
    s_cmp_lt_u32 s2, 216
    s_cbranch_scc1 L_w_l1
    buffer_load_ushort v16, v12, s[48:51], 0 offen offset:0
    buffer_load_ushort v17, v12, s[48:51], 0 offen offset:1152
    buffer_load_ushort v18, v12, s[48:51], 0 offen offset:2304
    buffer_load_ushort v19, v12, s[48:51], 0 offen offset:3456
    buffer_load_ushort v20, v12, s[48:51], 0 offen offset:128
    buffer_load_ushort v21, v12, s[48:51], 0 offen offset:1280
    buffer_load_ushort v22, v12, s[48:51], 0 offen offset:2432
    buffer_load_ushort v23, v12, s[48:51], 0 offen offset:3584
    buffer_load_ushort v24, v12, s[48:51], 0 offen offset:256
    buffer_load_ushort v25, v12, s[48:51], 0 offen offset:1408
    buffer_load_ushort v26, v12, s[48:51], 0 offen offset:2560
    buffer_load_ushort v27, v12, s[48:51], 0 offen offset:3712
L_w_l1:
    buffer_load_dwordx4 v[96:99], v1, s[36:39], s52 offen nt
    s_add_u32 s52, s52, s56
    buffer_load_dwordx4 v[100:103], v1, s[36:39], s52 offen nt
    s_add_u32 s52, s52, s56
    buffer_load_dwordx4 v[104:107], v1, s[36:39], s52 offen nt
    s_add_u32 s52, s52, s56
    s_cbranch_vccz Ll_45
    s_waitcnt vmcnt(2)
Ll_45:
    buffer_load_dwordx4 v[108:111], v1, s[36:39], s52 offen nt
    s_add_u32 s52, s52, s56
    s_cbranch_vccnz Ll_47
    s_waitcnt vmcnt(3)
    s_branch Ll_48
Ll_47:
    s_waitcnt vmcnt(2)
Ll_48:
    buffer_load_dwordx4 v[112:115], v1, s[36:39], s52 offen nt
    s_add_u32 s52, s52, s56
    s_cbranch_vccnz Ll_49
    s_waitcnt vmcnt(3)
    s_branch Ll_50
Ll_49:
    s_waitcnt vmcnt(2)
Ll_50:
    buffer_load_dwordx4 v[116:119], v1, s[36:39], s52 offen nt
    s_add_u32 s52, s52, s56
    s_cbranch_vccnz Ll_51
    s_waitcnt vmcnt(3)
    s_branch Ll_52
Ll_51:
    s_waitcnt vmcnt(2)
Ll_52:
    buffer_load_dwordx4 v[120:123], v1, s[36:39], s52 offen nt
    s_add_u32 s52, s52, s56
    s_cbranch_vccnz Ll_53
    s_waitcnt vmcnt(3)
    s_branch Ll_54
Ll_53:
    s_waitcnt vmcnt(2)
Ll_54:
    buffer_load_dwordx4 v[124:127], v1, s[36:39], s52 offen nt
    s_add_u32 s52, s52, s57
    s_cbranch_vccnz Ll_55
    s_waitcnt vmcnt(3)
    s_branch Ll_56
Ll_55:
    s_waitcnt vmcnt(2)
Ll_56:
    buffer_load_dwordx4 v[128:131], v1, s[36:39], s52 offen nt
    s_add_u32 s52, s52, s56
    s_cbranch_vccnz Ll_57
    s_waitcnt vmcnt(3)
    s_branch Ll_58
Ll_57:
    s_waitcnt vmcnt(2)
Ll_58:
    buffer_load_dwordx4 v[132:135], v1, s[36:39], s52 offen nt
    s_add_u32 s52, s52, s56
    s_cbranch_vccnz Ll_59
    s_waitcnt vmcnt(3)
    s_branch Ll_60
Ll_59:
    s_waitcnt vmcnt(2)
Ll_60:
    buffer_load_dwordx4 v[136:139], v1, s[36:39], s52 offen nt
    s_add_u32 s52, s52, s56
    s_cbranch_vccnz Ll_61
    s_waitcnt vmcnt(3)
    s_branch Ll_62
Ll_61:
    s_waitcnt vmcnt(2)
Ll_62:
    buffer_load_dwordx4 v[140:143], v1, s[36:39], s52 offen nt
    s_add_u32 s52, s52, s56
    s_cbranch_vccnz Ll_63
    s_waitcnt vmcnt(3)
    s_branch Ll_64
Ll_63:
    s_waitcnt vmcnt(2)
Ll_64:
    buffer_load_dwordx4 v[144:147], v1, s[36:39], s52 offen nt
    s_add_u32 s52, s52, s56
    s_cbranch_vccnz Ll_65
    s_waitcnt vmcnt(3)
    s_branch Ll_66
Ll_65:
    s_waitcnt vmcnt(2)
Ll_66:
    buffer_load_dwordx4 v[148:151], v1, s[36:39], s52 offen nt
    s_add_u32 s52, s52, s56
    s_cbranch_vccz L_w_l4
Lsp_67:
    s_sleep 1
    ds_read_b32 v5, v15 offset:19028
    s_waitcnt lgkmcnt(0)
    v_cmp_gt_u32 vcc, 5, v5
    s_cbranch_vccnz Lsp_67
    s_mov_b64 vcc, -1
L_w_l4:
    s_cbranch_vccnz Ll_68
    s_waitcnt vmcnt(3)
Ll_68:
    buffer_load_dwordx4 v[152:155], v1, s[36:39], s52 offen nt
    s_add_u32 s52, s52, s56
    s_cbranch_vccnz Ll_70
    s_waitcnt vmcnt(3)
Ll_70:
    buffer_load_dwordx4 v[156:159], v1, s[36:39], s52 offen nt
    s_add_u32 s52, s52, s57
    s_cmp_eq_u32 s59, 2
    s_cselect_b32 s52, 0x40000000, s52
    s_cbranch_vccnz Ll_72
    s_waitcnt vmcnt(3)
Ll_72:
    buffer_load_dwordx4 v[160:163], v1, s[36:39], s52 offen nt
    s_add_u32 s52, s52, s56
    s_cbranch_vccnz Ll_74
    s_waitcnt vmcnt(3)
Ll_74:
    buffer_load_dwordx4 v[164:167], v1, s[36:39], s52 offen nt
    s_add_u32 s52, s52, s56
    s_cbranch_vccnz Ll_76
    s_waitcnt vmcnt(3)
Ll_76:
    buffer_load_dwordx4 v[168:171], v1, s[36:39], s52 offen nt
    s_add_u32 s52, s52, s56
    s_cbranch_vccnz Ll_78
    s_waitcnt vmcnt(3)
Ll_78:
    buffer_load_dwordx4 v[172:175], v1, s[36:39], s52 offen nt
    s_add_u32 s52, s52, s56
    s_cbranch_vccnz Ll_80
    s_waitcnt vmcnt(3)
Ll_80:
    buffer_load_dwordx4 v[176:179], v1, s[36:39], s52 offen nt
    s_add_u32 s52, s52, s56
    s_cbranch_vccnz Ll_82
    s_waitcnt vmcnt(3)
Ll_82:
    buffer_load_dwordx4 v[180:183], v1, s[36:39], s52 offen nt
    s_add_u32 s52, s52, s56
    s_cbranch_vccnz Ll_84
    s_waitcnt vmcnt(3)
Ll_84:
    buffer_load_dwordx4 v[184:187], v1, s[36:39], s52 offen nt
    s_add_u32 s52, s52, s56
    s_cbranch_vccnz Ll_86
    s_waitcnt vmcnt(3)
Ll_86:
    buffer_load_dwordx4 v[188:191], v1, s[36:39], s52 offen nt
    s_cmp_lt_u32 s2, 216
    s_cbranch_scc1 L_w_l3
    s_waitcnt vmcnt(24)
    v_lshlrev_b32 v16, 16, v16
    v_lshlrev_b32 v17, 16, v17
    v_lshlrev_b32 v18, 16, v18
    v_lshlrev_b32 v19, 16, v19
    v_lshlrev_b32 v20, 16, v20
    v_lshlrev_b32 v21, 16, v21
    v_lshlrev_b32 v22, 16, v22
    v_lshlrev_b32 v23, 16, v23
    v_lshlrev_b32 v24, 16, v24
    v_lshlrev_b32 v25, 16, v25
    v_lshlrev_b32 v26, 16, v26
    v_lshlrev_b32 v27, 16, v27
    v_mul_f32 v28, 0xbfb8aa3b, v16
    v_mul_f32 v29, 0xbfb8aa3b, v17
    v_mul_f32 v30, 0xbfb8aa3b, v18
    v_mul_f32 v31, 0xbfb8aa3b, v19
    v_mul_f32 v32, 0xbfb8aa3b, v20
    v_mul_f32 v33, 0xbfb8aa3b, v21
    v_mul_f32 v34, 0xbfb8aa3b, v22
    v_mul_f32 v35, 0xbfb8aa3b, v23
    v_mul_f32 v36, 0xbfb8aa3b, v24
    v_mul_f32 v37, 0xbfb8aa3b, v25
    v_mul_f32 v38, 0xbfb8aa3b, v26
    v_mul_f32 v39, 0xbfb8aa3b, v27
    v_min_f32 v28, 0x42fc0000, v28
    v_min_f32 v29, 0x42fc0000, v29
    v_min_f32 v30, 0x42fc0000, v30
    v_min_f32 v31, 0x42fc0000, v31
    v_min_f32 v32, 0x42fc0000, v32
    v_min_f32 v33, 0x42fc0000, v33
    v_min_f32 v34, 0x42fc0000, v34
    v_min_f32 v35, 0x42fc0000, v35
    v_min_f32 v36, 0x42fc0000, v36
    v_min_f32 v37, 0x42fc0000, v37
    v_min_f32 v38, 0x42fc0000, v38
    v_min_f32 v39, 0x42fc0000, v39
    v_exp_f32 v28, v28
    v_exp_f32 v29, v29
    v_exp_f32 v30, v30
    v_exp_f32 v31, v31
    v_exp_f32 v32, v32
    v_exp_f32 v33, v33
    v_exp_f32 v34, v34
    v_exp_f32 v35, v35
    v_exp_f32 v36, v36
    v_exp_f32 v37, v37
    v_exp_f32 v38, v38
    v_exp_f32 v39, v39
    v_add_f32 v28, 1.0, v28
    v_add_f32 v29, 1.0, v29
    v_add_f32 v30, 1.0, v30
    v_add_f32 v31, 1.0, v31
    v_add_f32 v32, 1.0, v32
    v_add_f32 v33, 1.0, v33
    v_add_f32 v34, 1.0, v34
    v_add_f32 v35, 1.0, v35
    v_add_f32 v36, 1.0, v36
    v_add_f32 v37, 1.0, v37
    v_add_f32 v38, 1.0, v38
    v_add_f32 v39, 1.0, v39
    v_rcp_f32 v40, v28
    v_rcp_f32 v41, v29
    v_rcp_f32 v42, v30
    v_rcp_f32 v43, v31
    v_rcp_f32 v44, v32
    v_rcp_f32 v45, v33
    v_rcp_f32 v46, v34
    v_rcp_f32 v47, v35
    v_rcp_f32 v48, v36
    v_rcp_f32 v49, v37
    v_rcp_f32 v50, v38
    v_rcp_f32 v51, v39
    v_pk_mul_f32 v[52:53], v[16:17], v[40:41]
    v_pk_fma_f32 v[16:17], v[52:53], v[28:29], v[16:17] neg_lo:[1,0,0] neg_hi:[1,0,0]
    v_pk_fma_f32 v[16:17], v[16:17], v[40:41], v[52:53]
    v_pk_mul_f32 v[52:53], v[18:19], v[42:43]
    v_pk_fma_f32 v[18:19], v[52:53], v[30:31], v[18:19] neg_lo:[1,0,0] neg_hi:[1,0,0]
    v_pk_fma_f32 v[18:19], v[18:19], v[42:43], v[52:53]
    v_pk_mul_f32 v[52:53], v[20:21], v[44:45]
    v_pk_fma_f32 v[20:21], v[52:53], v[32:33], v[20:21] neg_lo:[1,0,0] neg_hi:[1,0,0]
    v_pk_fma_f32 v[20:21], v[20:21], v[44:45], v[52:53]
    v_pk_mul_f32 v[52:53], v[22:23], v[46:47]
    v_pk_fma_f32 v[22:23], v[52:53], v[34:35], v[22:23] neg_lo:[1,0,0] neg_hi:[1,0,0]
    v_pk_fma_f32 v[22:23], v[22:23], v[46:47], v[52:53]
    v_pk_mul_f32 v[52:53], v[24:25], v[48:49]
    v_pk_fma_f32 v[24:25], v[52:53], v[36:37], v[24:25] neg_lo:[1,0,0] neg_hi:[1,0,0]
    v_pk_fma_f32 v[24:25], v[24:25], v[48:49], v[52:53]
    v_pk_mul_f32 v[52:53], v[26:27], v[50:51]
    v_pk_fma_f32 v[26:27], v[52:53], v[38:39], v[26:27] neg_lo:[1,0,0] neg_hi:[1,0,0]
    v_pk_fma_f32 v[26:27], v[26:27], v[50:51], v[52:53]
    v_cvt_pk_bf16_f32 v28, v16, v17
    v_cvt_pk_bf16_f32 v29, v18, v19
    ds_write_b16 v12, v28 offset:0
    ds_write_b16_d16_hi v12, v28 offset:1168
    ds_write_b16 v12, v29 offset:2336
    ds_write_b16_d16_hi v12, v29 offset:3504
    v_cvt_pk_bf16_f32 v30, v20, v21
    v_cvt_pk_bf16_f32 v31, v22, v23
    ds_write_b16 v12, v30 offset:128
    ds_write_b16_d16_hi v12, v30 offset:1296
    ds_write_b16 v12, v31 offset:2464
    ds_write_b16_d16_hi v12, v31 offset:3632
    v_cvt_pk_bf16_f32 v32, v24, v25
    v_cvt_pk_bf16_f32 v33, v26, v27
    ds_write_b16 v12, v32 offset:256
    ds_write_b16_d16_hi v12, v32 offset:1424
    ds_write_b16 v12, v33 offset:2592
    ds_write_b16_d16_hi v12, v33 offset:3760
L_w_l3:
    s_mov_b64 exec, 1
    ds_add_u32 v15, v14 offset:19040
    s_mov_b64 exec, -1
    s_waitcnt vmcnt(16)
    v_perm_b32 v64, v100, v96, s60
    v_perm_b32 v65, v108, v104, s60
    v_perm_b32 v66, v116, v112, s60
    v_perm_b32 v67, v124, v120, s60
    v_perm_b32 v68, v100, v96, s61
    v_perm_b32 v69, v108, v104, s61
    v_perm_b32 v70, v116, v112, s61
    v_perm_b32 v71, v124, v120, s61
    v_perm_b32 v72, v101, v97, s60
    v_perm_b32 v73, v109, v105, s60
    v_perm_b32 v74, v117, v113, s60
    v_perm_b32 v75, v125, v121, s60
    v_perm_b32 v76, v101, v97, s61
    v_perm_b32 v77, v109, v105, s61
    v_perm_b32 v78, v117, v113, s61
    v_perm_b32 v79, v125, v121, s61
    v_perm_b32 v80, v102, v98, s60
    v_perm_b32 v81, v110, v106, s60
    v_perm_b32 v82, v118, v114, s60
    v_perm_b32 v83, v126, v122, s60
    v_perm_b32 v84, v102, v98, s61
    v_perm_b32 v85, v110, v106, s61
    v_perm_b32 v86, v118, v114, s61
    v_perm_b32 v87, v126, v122, s61
    v_perm_b32 v88, v103, v99, s60
    v_perm_b32 v89, v111, v107, s60
    v_perm_b32 v90, v119, v115, s60
    v_perm_b32 v91, v127, v123, s60
    v_perm_b32 v92, v103, v99, s61
    v_perm_b32 v93, v111, v107, s61
    v_perm_b32 v94, v119, v115, s61
    v_perm_b32 v95, v127, v123, s61
    s_waitcnt vmcnt(8)
    v_perm_b32 v96, v132, v128, s60
    v_perm_b32 v97, v140, v136, s60
    v_perm_b32 v98, v148, v144, s60
    v_perm_b32 v99, v156, v152, s60
    v_perm_b32 v100, v132, v128, s61
    v_perm_b32 v101, v140, v136, s61
    v_perm_b32 v102, v148, v144, s61
    v_perm_b32 v103, v156, v152, s61
    v_perm_b32 v104, v133, v129, s60
    v_perm_b32 v105, v141, v137, s60
    v_perm_b32 v106, v149, v145, s60
    v_perm_b32 v107, v157, v153, s60
    v_perm_b32 v108, v133, v129, s61
    v_perm_b32 v109, v141, v137, s61
    v_perm_b32 v110, v149, v145, s61
    v_perm_b32 v111, v157, v153, s61
    v_perm_b32 v112, v134, v130, s60
    v_perm_b32 v113, v142, v138, s60
    v_perm_b32 v114, v150, v146, s60
    v_perm_b32 v115, v158, v154, s60
    v_perm_b32 v116, v134, v130, s61
    v_perm_b32 v117, v142, v138, s61
    v_perm_b32 v118, v150, v146, s61
    v_perm_b32 v119, v158, v154, s61
    v_perm_b32 v120, v135, v131, s60
    v_perm_b32 v121, v143, v139, s60
    v_perm_b32 v122, v151, v147, s60
    v_perm_b32 v123, v159, v155, s60
    v_perm_b32 v124, v135, v131, s61
    v_perm_b32 v125, v143, v139, s61
    v_perm_b32 v126, v151, v147, s61
    v_perm_b32 v127, v159, v155, s61
    s_waitcnt vmcnt(0)
    v_perm_b32 v128, v164, v160, s60
    v_perm_b32 v129, v172, v168, s60
    v_perm_b32 v130, v180, v176, s60
    v_perm_b32 v131, v188, v184, s60
    v_perm_b32 v132, v164, v160, s61
    v_perm_b32 v133, v172, v168, s61
    v_perm_b32 v134, v180, v176, s61
    v_perm_b32 v135, v188, v184, s61
    v_perm_b32 v136, v165, v161, s60
    v_perm_b32 v137, v173, v169, s60
    v_perm_b32 v138, v181, v177, s60
    v_perm_b32 v139, v189, v185, s60
    v_perm_b32 v140, v165, v161, s61
    v_perm_b32 v141, v173, v169, s61
    v_perm_b32 v142, v181, v177, s61
    v_perm_b32 v143, v189, v185, s61
    v_perm_b32 v144, v166, v162, s60
    v_perm_b32 v145, v174, v170, s60
    v_perm_b32 v146, v182, v178, s60
    v_perm_b32 v147, v190, v186, s60
    v_perm_b32 v148, v166, v162, s61
    v_perm_b32 v149, v174, v170, s61
    v_perm_b32 v150, v182, v178, s61
    v_perm_b32 v151, v190, v186, s61
    v_perm_b32 v152, v167, v163, s60
    v_perm_b32 v153, v175, v171, s60
    v_perm_b32 v154, v183, v179, s60
    v_perm_b32 v155, v191, v187, s60
    v_perm_b32 v156, v167, v163, s61
    v_perm_b32 v157, v175, v171, s61
    v_perm_b32 v158, v183, v179, s61
    v_perm_b32 v159, v191, v187, s61
    s_cmp_lt_u32 s2, 216
    s_cbranch_scc0 L_w_l2
Lsp_88:
    ds_read_b32 v5, v15 offset:19008
    s_waitcnt lgkmcnt(0)
    v_cmp_gt_u32 vcc, 4, v5
    s_cbranch_vccnz Lsp_88
L_w_l2:
    ds_read_b128 v[16:19], v2 offset:0
    ds_read_b128 v[20:23], v3 offset:0
    ds_read_b128 v[24:27], v2 offset:128
    ds_read_b128 v[28:31], v3 offset:128
    ds_read_b128 v[32:35], v8
    ds_read_b128 v[36:39], v9
    s_waitcnt lgkmcnt(5)
    v_mfma_f32_16x16x32_bf16 v[40:43], v[16:19], v[64:67], 0
    v_mfma_f32_16x16x32_bf16 v[44:47], v[16:19], v[72:75], 0
    v_mfma_f32_16x16x32_bf16 v[48:51], v[16:19], v[80:83], 0
    v_mfma_f32_16x16x32_bf16 v[52:55], v[16:19], v[88:91], 0
    s_waitcnt lgkmcnt(4)
    v_mfma_f32_16x16x32_bf16 v[40:43], v[20:23], v[68:71], v[40:43]
    v_mfma_f32_16x16x32_bf16 v[44:47], v[20:23], v[76:79], v[44:47]
    v_mfma_f32_16x16x32_bf16 v[48:51], v[20:23], v[84:87], v[48:51]
    v_mfma_f32_16x16x32_bf16 v[52:55], v[20:23], v[92:95], v[52:55]
    s_waitcnt lgkmcnt(3)
    v_mfma_f32_16x16x32_bf16 v[40:43], v[24:27], v[96:99], v[40:43]
    v_mfma_f32_16x16x32_bf16 v[44:47], v[24:27], v[104:107], v[44:47]
    v_mfma_f32_16x16x32_bf16 v[48:51], v[24:27], v[112:115], v[48:51]
    v_mfma_f32_16x16x32_bf16 v[52:55], v[24:27], v[120:123], v[52:55]
    s_waitcnt lgkmcnt(2)
    v_mfma_f32_16x16x32_bf16 v[40:43], v[28:31], v[100:103], v[40:43]
    v_mfma_f32_16x16x32_bf16 v[44:47], v[28:31], v[108:111], v[44:47]
    v_mfma_f32_16x16x32_bf16 v[48:51], v[28:31], v[116:119], v[48:51]
    v_mfma_f32_16x16x32_bf16 v[52:55], v[28:31], v[124:127], v[52:55]
    s_waitcnt lgkmcnt(1)
    v_mfma_f32_16x16x32_bf16 v[40:43], v[32:35], v[128:131], v[40:43]
    v_mfma_f32_16x16x32_bf16 v[44:47], v[32:35], v[136:139], v[44:47]
    v_mfma_f32_16x16x32_bf16 v[48:51], v[32:35], v[144:147], v[48:51]
    v_mfma_f32_16x16x32_bf16 v[52:55], v[32:35], v[152:155], v[52:55]
    s_waitcnt lgkmcnt(0)
    v_mfma_f32_16x16x32_bf16 v[40:43], v[36:39], v[132:135], v[40:43]
    v_mfma_f32_16x16x32_bf16 v[44:47], v[36:39], v[140:143], v[44:47]
    v_mfma_f32_16x16x32_bf16 v[48:51], v[36:39], v[148:151], v[48:51]
    v_mfma_f32_16x16x32_bf16 v[52:55], v[36:39], v[156:159], v[52:55]
    s_mov_b32 exec_lo, 0xff0000ff
    s_mov_b32 exec_hi, 0xff0000ff
    s_nop 2
    ds_write_b128 v4, v[40:43] offset:4672
    ds_write_b128 v4, v[44:47] offset:4960
    ds_write_b128 v4, v[48:51] offset:5248
    ds_write_b128 v4, v[52:55] offset:5536
    s_mov_b64 exec, 1
    ds_add_u32 v15, v14 offset:19012
    s_mov_b64 exec, -1
    s_endpgm
L_w_ffn:
    s_cmp_lt_u32 s101, 54
    s_cbranch_scc1 L_w_ff1
    s_waitcnt lgkmcnt(0)
    s_add_u32 s100, s100, 0x01010101
    s_bfe_u32 s96, s100, 0x80000
    s_bfe_u32 s97, s100, 0x80008
    s_bfe_u32 s98, s100, 0x80010
    s_bfe_u32 s99, s100, 0x80018
L_w_ff1:
    s_mov_b32 s44, s34
    s_mov_b32 s45, s35
    s_mov_b32 s46, 8388608
    s_mov_b32 s47, 0x20000
    s_mov_b32 s40, s24
    s_mov_b32 s41, s25
    s_mov_b32 s42, 5308416
    s_mov_b32 s43, 0x20000
    s_lshr_b32 s52, s20, 7
    s_add_u32 s52, s52, s4
    s_sub_u32 s52, 3, s52
    s_and_b32 s52, s52, 7
    s_lshl_b32 s52, s52, 1
    s_add_u32 s52, s52, s5
    s_add_u32 s52, s52, 4
    s_cmp_ge_u32 s52, 18
    s_cselect_b32 s53, 18, 0
    s_sub_u32 s52, s52, s53
    s_mul_i32 s6, s4, 18
    s_add_u32 s6, s6, s52
    v_and_b32 v5, 8, v0
    v_lshrrev_b32 v6, 4, v0
    v_lshl_add_u32 v5, v6, 1, v5
    v_mul_u32_u24 v5, 36864, v5
    v_and_b32 v7, 3, v0
    v_lshl_add_u32 v5, v7, 4, v5
    s_mul_i32 s52, s7, 1769472
    s_lshl_b32 s53, s6, 6
    s_add_u32 s52, s52, s53
    v_add_u32 v5, s52, v5
    v_and_b32 v7, 4, v0
    v_cmp_eq_u32 vcc, 0, v7
    v_mov_b32 v61, s22
    v_mov_b32 v62, s20
    v_cndmask_b32 v10, v61, v62, vcc
    v_mov_b32 v61, s23
    v_mov_b32 v62, s21
    v_cndmask_b32 v11, v61, v62, vcc
    v_add_co_u32 v10, vcc, v10, v5
    s_nop 1
    v_addc_co_u32 v11, vcc, 0, v11, vcc
    s_movk_i32 s54, 9216
    s_mov_b32 s55, 0
    s_mov_b32 s57, 0
    s_and_b32 s56, s5, 1
    s_xor_b32 s56, s56, 1
    s_mul_i32 s56, s56, 36864
    v_lshl_add_u64 v[62:63], v[10:11], 0, s[56:57]
    s_xor_b32 s56, s56, 36864
    v_lshl_add_u64 v[10:11], v[10:11], 0, s[56:57]
    s_mov_b32 s56, 562176
    v_mul_u32_u24 v1, 9216, v6
    v_and_b32 v7, 15, v0
    v_lshl_add_u32 v1, v7, 4, v1
    s_mul_i32 s52, s6, 36864
    s_mul_i32 s53, s7, 384
    s_add_u32 s52, s52, s53
    s_add_u32 s53, s52, 4608
    v_and_b32 v5, 8, v0
    v_add_u32 v5, v5, v6
    v_mul_u32_u24 v12, 18432, v5
    v_and_b32 v5, 7, v0
    v_lshl_add_u32 v12, v5, 4, v12
    s_mul_i32 s48, s7, 442368
    s_lshl_b32 s49, s6, 7
    s_add_u32 s48, s48, s49
    s_add_u32 s48, s48, 1257472
    s_add_u32 s49, s48, 73728
    s_add_u32 s50, s48, 294912
    s_add_u32 s51, s48, 368640
    v_and_b32 v13, 7, v0
    v_mul_u32_u24 v13, 144, v13
    v_lshrrev_b32 v5, 3, v0
    v_lshl_add_u32 v13, v5, 4, v13
    s_lshl_b32 s58, s7, 8
    s_add_u32 s58, s58, 15680
    v_lshrrev_b32 v5, 5, v0
    v_lshlrev_b32 v5, 7, v5
    v_and_b32 v7, 31, v0
    v_lshl_add_u32 v5, v7, 1, v5
    v_add_u32 v60, s58, v5
    v_and_b32 v5, 3, v0
    v_lshlrev_b32 v5, 6, v5
    v_lshl_add_u32 v5, v6, 4, v5
    v_add_u32 v5, s58, v5
    v_bfe_u32 v7, v0, 2, 2
    v_mov_b32 v61, 18496
    v_mov_b32 v8, 0xff
    v_cmp_eq_u32 vcc, 0, v7
    s_nop 1
    v_cndmask_b32 v56, v61, v5, vcc
    v_cmp_eq_u32 vcc, 1, v7
    s_nop 1
    v_cndmask_b32 v57, v61, v5, vcc
    v_cmp_eq_u32 vcc, 2, v7
    s_nop 1
    v_cndmask_b32 v58, v61, v5, vcc
    v_cmp_eq_u32 vcc, 3, v7
    s_nop 1
    v_cndmask_b32 v59, v61, v5, vcc
    s_lshl_b32 s58, s6, 6
    s_add_u32 s58, s58, s20
    s_bfe_u32 s58, s58, 0x30007
    s_cmp_eq_u32 s58, 9
    s_cselect_b32 s58, 4, 8
Lsp_89:
    s_sleep 2
    ds_read_b32 v5, v15 offset:19020
    s_waitcnt lgkmcnt(0)
    v_cmp_gt_u32 vcc, s58, v5
    s_cbranch_vccnz Lsp_89
    s_cmp_eq_u32 s58, 8
    buffer_load_dwordx4 v[192:195], v1, s[40:43], s52 offen offset:0 nt
    buffer_load_dwordx4 v[196:199], v1, s[40:43], s52 offen offset:1152 nt
    buffer_load_dwordx4 v[200:203], v1, s[40:43], s52 offen offset:2304 nt
    buffer_load_dwordx4 v[204:207], v1, s[40:43], s52 offen offset:3456 nt
    s_cmp_eq_u32 s58, 8
    s_cbranch_scc0 Lg_90
Lsp_91:
    s_sleep 1
    ds_read_b32 v5, v15 offset:19028
    s_waitcnt lgkmcnt(0)
    v_cmp_gt_u32 vcc, 5, v5
    s_cbranch_vccnz Lsp_91
Lg_90:
    s_cmp_eq_u32 s58, 8
    s_cbranch_scc1 Lg_92
    s_waitcnt vmcnt(3)
Lg_92:
    buffer_load_dwordx4 v[208:211], v1, s[40:43], s53 offen offset:0 nt
    s_cbranch_scc1 Lg_93
    s_waitcnt vmcnt(3)
Lg_93:
    buffer_load_dwordx4 v[212:215], v1, s[40:43], s53 offen offset:1152 nt
    s_cbranch_scc1 Lg_94
    s_waitcnt vmcnt(3)
Lg_94:
    buffer_load_dwordx4 v[216:219], v1, s[40:43], s53 offen offset:2304 nt
    s_cbranch_scc1 Lg_95
    s_waitcnt vmcnt(3)
Lg_95:
    buffer_load_dwordx4 v[220:223], v1, s[40:43], s53 offen offset:3456 nt
    s_cbranch_scc1 Lg_96
    s_waitcnt vmcnt(3)
Lg_96:
    s_mov_b32 exec_lo, 0xff00ff
    s_mov_b32 exec_hi, 0xff00ff
    buffer_load_dwordx4 v[224:227], v1, s[40:43], s52 offen offset:256 nt
    s_cbranch_scc1 Lg_97
    s_waitcnt vmcnt(4)
Lg_97:
    buffer_load_dwordx4 v[228:231], v1, s[40:43], s52 offen offset:1408 nt
    s_cbranch_scc1 Lg_98
    s_waitcnt vmcnt(4)
Lg_98:
    buffer_load_dwordx4 v[232:235], v1, s[40:43], s52 offen offset:2560 nt
    s_cbranch_scc1 Lg_99
    s_waitcnt vmcnt(5)
Lg_99:
    buffer_load_dwordx4 v[236:239], v1, s[40:43], s52 offen offset:3712 nt
    s_cbranch_scc1 Lg_100
    s_waitcnt vmcnt(5)
Lg_100:
    buffer_load_dwordx4 v[240:243], v1, s[40:43], s53 offen offset:256 nt
    s_cbranch_scc1 Lg_101
    s_waitcnt vmcnt(6)
Lg_101:
    s_waitcnt vmcnt(12)
    buffer_load_dwordx4 v[244:247], v1, s[40:43], s53 offen offset:1408 nt
    s_cbranch_scc1 Lg_102
    s_waitcnt vmcnt(6)
Lg_102:
    s_waitcnt vmcnt(13)
    buffer_load_dwordx4 v[248:251], v1, s[40:43], s53 offen offset:2560 nt
    s_cbranch_scc1 Lg_103
    s_waitcnt vmcnt(7)
Lg_103:
    s_waitcnt vmcnt(13)
    buffer_load_dwordx4 v[252:255], v1, s[40:43], s53 offen offset:3712 nt
    s_cbranch_scc1 Lg_104
    s_waitcnt vmcnt(4)
Lg_104:
    s_waitcnt vmcnt(12)
    s_mov_b64 exec, -1
    global_load_dwordx4 v[96:99], v[10:11], off
    s_cbranch_scc1 Lg_105
    s_waitcnt vmcnt(1)
Lg_105:
    s_waitcnt vmcnt(11)
    v_lshl_add_u64 v[10:11], v[10:11], 0, s[54:55]
    global_load_dwordx4 v[100:103], v[10:11], off
    s_cbranch_scc1 Lg_106
    s_waitcnt vmcnt(1)
Lg_106:
    s_waitcnt vmcnt(10)
    v_lshl_add_u64 v[10:11], v[10:11], 0, s[54:55]
    global_load_dwordx4 v[104:107], v[10:11], off
    s_cbranch_scc1 Lg_107
    s_waitcnt vmcnt(1)
Lg_107:
    s_waitcnt vmcnt(8)
    v_lshl_add_u64 v[10:11], v[10:11], 0, s[54:55]
    global_load_dwordx4 v[108:111], v[10:11], off
    s_cbranch_scc1 Lg_108
    s_waitcnt vmcnt(1)
Lg_108:
    s_waitcnt vmcnt(5)
    v_lshl_add_u64 v[10:11], v[10:11], 0, s[56:57]
    global_load_dwordx4 v[128:131], v[10:11], off
    s_cbranch_scc1 Lg_109
    s_waitcnt vmcnt(1)
Lg_109:
    s_waitcnt vmcnt(4)
    v_lshl_add_u64 v[10:11], v[10:11], 0, s[54:55]
    global_load_dwordx4 v[132:135], v[10:11], off
    s_cbranch_scc1 Lg_110
    s_waitcnt vmcnt(1)
Lg_110:
    s_waitcnt vmcnt(4)
    v_lshl_add_u64 v[10:11], v[10:11], 0, s[54:55]
    global_load_dwordx4 v[136:139], v[10:11], off
    s_cbranch_scc1 Lg_111
    s_waitcnt vmcnt(1)
Lg_111:
    s_waitcnt vmcnt(4)
    v_lshl_add_u64 v[10:11], v[10:11], 0, s[54:55]
    global_load_dwordx4 v[140:143], v[10:11], off
    s_cbranch_scc1 Lg_112
    s_waitcnt vmcnt(1)
Lg_112:
    s_waitcnt vmcnt(4)
    v_lshl_add_u64 v[10:11], v[10:11], 0, s[56:57]
    global_load_dwordx4 v[160:163], v[10:11], off
    s_cbranch_scc1 Lg_113
    s_waitcnt vmcnt(1)
Lg_113:
    s_waitcnt vmcnt(4)
    v_lshl_add_u64 v[10:11], v[10:11], 0, s[54:55]
    global_load_dwordx4 v[164:167], v[10:11], off
    s_cbranch_scc1 Lg_114
    s_waitcnt vmcnt(1)
Lg_114:
    s_waitcnt vmcnt(4)
    v_lshl_add_u64 v[10:11], v[10:11], 0, s[54:55]
    global_load_dwordx4 v[168:171], v[10:11], off
    s_cbranch_scc1 Lg_115
    s_waitcnt vmcnt(1)
Lg_115:
    s_waitcnt vmcnt(4)
    v_lshl_add_u64 v[10:11], v[10:11], 0, s[54:55]
    global_load_dwordx4 v[172:175], v[10:11], off
    s_cmp_eq_u32 s58, 4
    s_cbranch_scc0 Lg_116
Lsp_117:
    s_sleep 1
    ds_read_b32 v5, v15 offset:19028
    s_waitcnt lgkmcnt(0)
    v_cmp_gt_u32 vcc, 5, v5
    s_cbranch_vccnz Lsp_117
Lg_116:
    s_waitcnt vmcnt(4)
    v_mov_b32 v10, v62
    v_mov_b32 v11, v63
    global_load_dwordx4 v[112:115], v[10:11], off nt
    s_waitcnt vmcnt(4)
    v_lshl_add_u64 v[10:11], v[10:11], 0, s[54:55]
    global_load_dwordx4 v[116:119], v[10:11], off nt
    s_waitcnt vmcnt(4)
    v_lshl_add_u64 v[10:11], v[10:11], 0, s[54:55]
    global_load_dwordx4 v[120:123], v[10:11], off nt
    s_waitcnt vmcnt(4)
    v_lshl_add_u64 v[10:11], v[10:11], 0, s[54:55]
    global_load_dwordx4 v[124:127], v[10:11], off nt
    s_waitcnt vmcnt(4)
    v_lshl_add_u64 v[10:11], v[10:11], 0, s[56:57]
    global_load_dwordx4 v[144:147], v[10:11], off nt
    s_waitcnt vmcnt(4)
    v_lshl_add_u64 v[10:11], v[10:11], 0, s[54:55]
    global_load_dwordx4 v[148:151], v[10:11], off nt
    s_waitcnt vmcnt(4)
    v_lshl_add_u64 v[10:11], v[10:11], 0, s[54:55]
    global_load_dwordx4 v[152:155], v[10:11], off nt
    s_waitcnt vmcnt(4)
    v_lshl_add_u64 v[10:11], v[10:11], 0, s[54:55]
    global_load_dwordx4 v[156:159], v[10:11], off nt
    s_waitcnt vmcnt(4)
    v_lshl_add_u64 v[10:11], v[10:11], 0, s[56:57]
    global_load_dwordx4 v[176:179], v[10:11], off nt
    s_mov_b64 exec, 1
    ds_add_u32 v15, v14 offset:19040
    s_mov_b64 exec, -1
    s_waitcnt vmcnt(4)
    v_lshl_add_u64 v[10:11], v[10:11], 0, s[54:55]
    global_load_dwordx4 v[180:183], v[10:11], off nt
    s_waitcnt vmcnt(4)
    v_lshl_add_u64 v[10:11], v[10:11], 0, s[54:55]
    global_load_dwordx4 v[184:187], v[10:11], off nt
    s_waitcnt vmcnt(4)
    v_lshl_add_u64 v[10:11], v[10:11], 0, s[54:55]
    global_load_dwordx4 v[188:191], v[10:11], off nt
    s_mov_b64 exec, 1
    ds_add_u32 v15, v14 offset:19040
    s_mov_b64 exec, -1
    s_waitcnt vmcnt(24)
    v_perm_b32 v64, v196, v192, s60
    v_perm_b32 v65, v204, v200, s60
    v_perm_b32 v66, v212, v208, s60
    v_perm_b32 v67, v220, v216, s60
    v_perm_b32 v68, v196, v192, s61
    v_perm_b32 v69, v204, v200, s61
    v_perm_b32 v70, v212, v208, s61
    v_perm_b32 v71, v220, v216, s61
    v_perm_b32 v72, v197, v193, s60
    v_perm_b32 v73, v205, v201, s60
    v_perm_b32 v74, v213, v209, s60
    v_perm_b32 v75, v221, v217, s60
    v_perm_b32 v76, v197, v193, s61
    v_perm_b32 v77, v205, v201, s61
    v_perm_b32 v78, v213, v209, s61
    v_perm_b32 v79, v221, v217, s61
    v_perm_b32 v80, v198, v194, s60
    v_perm_b32 v81, v206, v202, s60
    v_perm_b32 v82, v214, v210, s60
    v_perm_b32 v83, v222, v218, s60
    v_perm_b32 v84, v198, v194, s61
    v_perm_b32 v85, v206, v202, s61
    v_perm_b32 v86, v214, v210, s61
    v_perm_b32 v87, v222, v218, s61
    v_perm_b32 v88, v199, v195, s60
    v_perm_b32 v89, v207, v203, s60
    v_perm_b32 v90, v215, v211, s60
    v_perm_b32 v91, v223, v219, s60
    v_perm_b32 v92, v199, v195, s61
    v_perm_b32 v93, v207, v203, s61
    v_perm_b32 v94, v215, v211, s61
    v_perm_b32 v95, v223, v219, s61
    v_perm_b32 v192, v228, v224, s60
    v_perm_b32 v193, v236, v232, s60
    v_perm_b32 v194, v244, v240, s60
    v_perm_b32 v195, v252, v248, s60
    v_perm_b32 v196, v228, v224, s61
    v_perm_b32 v197, v236, v232, s61
    v_perm_b32 v198, v244, v240, s61
    v_perm_b32 v199, v252, v248, s61
    v_perm_b32 v200, v229, v225, s60
    v_perm_b32 v201, v237, v233, s60
    v_perm_b32 v202, v245, v241, s60
    v_perm_b32 v203, v253, v249, s60
    v_perm_b32 v204, v229, v225, s61
    v_perm_b32 v205, v237, v233, s61
    v_perm_b32 v206, v245, v241, s61
    v_perm_b32 v207, v253, v249, s61
    v_perm_b32 v208, v230, v226, s60
    v_perm_b32 v209, v238, v234, s60
    v_perm_b32 v210, v246, v242, s60
    v_perm_b32 v211, v254, v250, s60
    v_perm_b32 v212, v230, v226, s61
    v_perm_b32 v213, v238, v234, s61
    v_perm_b32 v214, v246, v242, s61
    v_perm_b32 v215, v254, v250, s61
    v_perm_b32 v216, v231, v227, s60
    v_perm_b32 v217, v239, v235, s60
    v_perm_b32 v218, v247, v243, s60
    v_perm_b32 v219, v255, v251, s60
    v_perm_b32 v220, v231, v227, s61
    v_perm_b32 v221, v239, v235, s61
    v_perm_b32 v222, v247, v243, s61
    v_perm_b32 v223, v255, v251, s61
    s_waitcnt vmcnt(8)
    v_perm_b32 v224, v100, v96, s60
    v_perm_b32 v225, v108, v104, s60
    v_perm_b32 v226, v116, v112, s60
    v_perm_b32 v227, v124, v120, s60
    v_perm_b32 v228, v100, v96, s61
    v_perm_b32 v229, v108, v104, s61
    v_perm_b32 v230, v116, v112, s61
    v_perm_b32 v231, v124, v120, s61
    v_perm_b32 v232, v101, v97, s60
    v_perm_b32 v233, v109, v105, s60
    v_perm_b32 v234, v117, v113, s60
    v_perm_b32 v235, v125, v121, s60
    v_perm_b32 v236, v101, v97, s61
    v_perm_b32 v237, v109, v105, s61
    v_perm_b32 v238, v117, v113, s61
    v_perm_b32 v239, v125, v121, s61
    v_perm_b32 v240, v102, v98, s60
    v_perm_b32 v241, v110, v106, s60
    v_perm_b32 v242, v118, v114, s60
    v_perm_b32 v243, v126, v122, s60
    v_perm_b32 v244, v102, v98, s61
    v_perm_b32 v245, v110, v106, s61
    v_perm_b32 v246, v118, v114, s61
    v_perm_b32 v247, v126, v122, s61
    v_perm_b32 v248, v103, v99, s60
    v_perm_b32 v249, v111, v107, s60
    v_perm_b32 v250, v119, v115, s60
    v_perm_b32 v251, v127, v123, s60
    v_perm_b32 v252, v103, v99, s61
    v_perm_b32 v253, v111, v107, s61
    v_perm_b32 v254, v119, v115, s61
    v_perm_b32 v255, v127, v123, s61
    s_waitcnt vmcnt(4)
    v_perm_b32 v96, v132, v128, s60
    v_perm_b32 v97, v140, v136, s60
    v_perm_b32 v98, v148, v144, s60
    v_perm_b32 v99, v156, v152, s60
    v_perm_b32 v100, v132, v128, s61
    v_perm_b32 v101, v140, v136, s61
    v_perm_b32 v102, v148, v144, s61
    v_perm_b32 v103, v156, v152, s61
    v_perm_b32 v104, v133, v129, s60
    v_perm_b32 v105, v141, v137, s60
    v_perm_b32 v106, v149, v145, s60
    v_perm_b32 v107, v157, v153, s60
    v_perm_b32 v108, v133, v129, s61
    v_perm_b32 v109, v141, v137, s61
    v_perm_b32 v110, v149, v145, s61
    v_perm_b32 v111, v157, v153, s61
    v_perm_b32 v112, v134, v130, s60
    v_perm_b32 v113, v142, v138, s60
    v_perm_b32 v114, v150, v146, s60
    v_perm_b32 v115, v158, v154, s60
    v_perm_b32 v116, v134, v130, s61
    v_perm_b32 v117, v142, v138, s61
    v_perm_b32 v118, v150, v146, s61
    v_perm_b32 v119, v158, v154, s61
    v_perm_b32 v120, v135, v131, s60
    v_perm_b32 v121, v143, v139, s60
    v_perm_b32 v122, v151, v147, s60
    v_perm_b32 v123, v159, v155, s60
    v_perm_b32 v124, v135, v131, s61
    v_perm_b32 v125, v143, v139, s61
    v_perm_b32 v126, v151, v147, s61
    v_perm_b32 v127, v159, v155, s61
    s_waitcnt vmcnt(0)
    v_perm_b32 v128, v164, v160, s60
    v_perm_b32 v129, v172, v168, s60
    v_perm_b32 v130, v180, v176, s60
    v_perm_b32 v131, v188, v184, s60
    v_perm_b32 v132, v164, v160, s61
    v_perm_b32 v133, v172, v168, s61
    v_perm_b32 v134, v180, v176, s61
    v_perm_b32 v135, v188, v184, s61
    v_perm_b32 v136, v165, v161, s60
    v_perm_b32 v137, v173, v169, s60
    v_perm_b32 v138, v181, v177, s60
    v_perm_b32 v139, v189, v185, s60
    v_perm_b32 v140, v165, v161, s61
    v_perm_b32 v141, v173, v169, s61
    v_perm_b32 v142, v181, v177, s61
    v_perm_b32 v143, v189, v185, s61
    v_perm_b32 v144, v166, v162, s60
    v_perm_b32 v145, v174, v170, s60
    v_perm_b32 v146, v182, v178, s60
    v_perm_b32 v147, v190, v186, s60
    v_perm_b32 v148, v166, v162, s61
    v_perm_b32 v149, v174, v170, s61
    v_perm_b32 v150, v182, v178, s61
    v_perm_b32 v151, v190, v186, s61
    v_perm_b32 v152, v167, v163, s60
    v_perm_b32 v153, v175, v171, s60
    v_perm_b32 v154, v183, v179, s60
    v_perm_b32 v155, v191, v187, s60
    v_perm_b32 v156, v167, v163, s61
    v_perm_b32 v157, v175, v171, s61
    v_perm_b32 v158, v183, v179, s61
    v_perm_b32 v159, v191, v187, s61
Lsp_118:
    ds_read_b32 v5, v15 offset:19008
    s_waitcnt lgkmcnt(0)
    v_cmp_gt_u32 vcc, 4, v5
    s_cbranch_vccnz Lsp_118
    ds_read_b128 v[16:19], v2 offset:0
    ds_read_b128 v[20:23], v3 offset:0
    ds_read_b128 v[24:27], v2 offset:128
    ds_read_b128 v[28:31], v3 offset:128
    ds_read_b128 v[32:35], v2 offset:256
    ds_read_b128 v[36:39], v3 offset:256
    s_waitcnt lgkmcnt(5)
    v_mfma_f32_16x16x32_bf16 v[40:43], v[16:19], v[224:227], 0
    v_mfma_f32_16x16x32_bf16 v[44:47], v[16:19], v[232:235], 0
    v_mfma_f32_16x16x32_bf16 v[48:51], v[16:19], v[240:243], 0
    v_mfma_f32_16x16x32_bf16 v[52:55], v[16:19], v[248:251], 0
    s_waitcnt lgkmcnt(4)
    v_mfma_f32_16x16x32_bf16 v[40:43], v[20:23], v[228:231], v[40:43]
    v_mfma_f32_16x16x32_bf16 v[44:47], v[20:23], v[236:239], v[44:47]
    v_mfma_f32_16x16x32_bf16 v[48:51], v[20:23], v[244:247], v[48:51]
    v_mfma_f32_16x16x32_bf16 v[52:55], v[20:23], v[252:255], v[52:55]
    s_waitcnt lgkmcnt(3)
    v_mfma_f32_16x16x32_bf16 v[40:43], v[24:27], v[96:99], v[40:43]
    v_mfma_f32_16x16x32_bf16 v[44:47], v[24:27], v[104:107], v[44:47]
    v_mfma_f32_16x16x32_bf16 v[48:51], v[24:27], v[112:115], v[48:51]
    v_mfma_f32_16x16x32_bf16 v[52:55], v[24:27], v[120:123], v[52:55]
    s_waitcnt lgkmcnt(2)
    v_mfma_f32_16x16x32_bf16 v[40:43], v[28:31], v[100:103], v[40:43]
    v_mfma_f32_16x16x32_bf16 v[44:47], v[28:31], v[108:111], v[44:47]
    v_mfma_f32_16x16x32_bf16 v[48:51], v[28:31], v[116:119], v[48:51]
    v_mfma_f32_16x16x32_bf16 v[52:55], v[28:31], v[124:127], v[52:55]
    s_waitcnt lgkmcnt(1)
    v_mfma_f32_16x16x32_bf16 v[40:43], v[32:35], v[128:131], v[40:43]
    v_mfma_f32_16x16x32_bf16 v[44:47], v[32:35], v[136:139], v[44:47]
    v_mfma_f32_16x16x32_bf16 v[48:51], v[32:35], v[144:147], v[48:51]
    v_mfma_f32_16x16x32_bf16 v[52:55], v[32:35], v[152:155], v[52:55]
    s_waitcnt lgkmcnt(0)
    v_mfma_f32_16x16x32_bf16 v[40:43], v[36:39], v[132:135], v[40:43]
    v_mfma_f32_16x16x32_bf16 v[44:47], v[36:39], v[140:143], v[44:47]
    v_mfma_f32_16x16x32_bf16 v[48:51], v[36:39], v[148:151], v[48:51]
    v_mfma_f32_16x16x32_bf16 v[52:55], v[36:39], v[156:159], v[52:55]
    s_mov_b32 exec_lo, 0xff0000ff
    s_mov_b32 exec_hi, 0xff0000ff
    s_nop 2
    ds_write_b128 v4, v[40:43] offset:4672
    ds_write_b128 v4, v[44:47] offset:4960
    ds_write_b128 v4, v[48:51] offset:5248
    ds_write_b128 v4, v[52:55] offset:5536
    s_mov_b64 exec, 1
    ds_add_u32 v15, v14 offset:19012
    s_mov_b64 exec, -1
Lsp_119:
    ds_read_b32 v5, v15 offset:19012
    s_waitcnt lgkmcnt(0)
    v_cmp_gt_u32 vcc, 3, v5
    s_cbranch_vccnz Lsp_119
    ds_read_b128 v[16:19], v13 offset:4672
    ds_read_b128 v[20:23], v13 offset:5824
    ds_read_b128 v[24:27], v13 offset:6976
    ds_read_b128 v[28:31], v13 offset:8128
    ds_read_b128 v[32:35], v13 offset:9280
    ds_read_b128 v[36:39], v13 offset:10432
    s_waitcnt lgkmcnt(4)
    v_pk_add_f32 v[16:17], v[16:17], v[20:21]
    v_pk_add_f32 v[18:19], v[18:19], v[22:23]
    s_waitcnt lgkmcnt(3)
    v_pk_add_f32 v[16:17], v[16:17], v[24:25]
    v_pk_add_f32 v[18:19], v[18:19], v[26:27]
    s_waitcnt lgkmcnt(2)
    v_pk_add_f32 v[16:17], v[16:17], v[28:29]
    v_pk_add_f32 v[18:19], v[18:19], v[30:31]
    s_waitcnt lgkmcnt(1)
    v_pk_add_f32 v[16:17], v[16:17], v[32:33]
    v_pk_add_f32 v[18:19], v[18:19], v[34:35]
    s_waitcnt lgkmcnt(0)
    v_pk_add_f32 v[16:17], v[16:17], v[36:37]
    v_pk_add_f32 v[18:19], v[18:19], v[38:39]
    v_cvt_pk_bf16_f32 v20, v16, v17
    v_cvt_pk_bf16_f32 v21, v18, v19
    v_and_b32 v17, 0xffff0000, v20
    v_lshlrev_b32 v16, 16, v20
    v_and_b32 v19, 0xffff0000, v21
    v_lshlrev_b32 v18, 16, v21
    v_mov_b32 v22, 0xc0135761
    s_nop 0
    v_permlane32_swap_b32 v16, v18
    v_permlane32_swap_b32 v17, v19
    v_mul_f32 v20, v16, v16
    v_mul_f32 v21, v17, v17
    v_fmamk_f32 v20, v20, 0xbdd2d3e8, v22
    v_fmamk_f32 v21, v21, 0xbdd2d3e8, v22
    v_mul_f32 v20, v20, v16
    v_mul_f32 v21, v21, v17
    v_exp_f32 v20, v20
    v_exp_f32 v21, v21
    v_add_f32 v20, 1.0, v20
    v_add_f32 v21, 1.0, v21
    v_rcp_f32 v20, v20
    v_rcp_f32 v21, v21
    s_nop 0
    v_pk_mul_f32 v[16:17], v[16:17], v[20:21]
    v_cvt_pk_bf16_f32 v20, v16, v17
    v_lshlrev_b32 v16, 16, v20
    v_and_b32 v17, 0xffff0000, v20
    v_pk_mul_f32 v[16:17], v[16:17], v[18:19]
    v_cvt_pk_bf16_f32 v20, v16, v17
    ds_write_b16 v60, v20
    ds_write_b16_d16_hi v60, v20 offset:64
    ds_read_b128 v[24:27], v56
    ds_read_b128 v[28:31], v57
    ds_read_b128 v[32:35], v58
    ds_read_b128 v[36:39], v59
    s_waitcnt lgkmcnt(0)
    v_mfma_f32_16x16x32_bf16 v[40:43], v[24:27], v[64:67], 0
    v_mfma_f32_16x16x32_bf16 v[40:43], v[28:31], v[68:71], v[40:43]
    v_mfma_f32_16x16x32_bf16 v[40:43], v[32:35], v[72:75], v[40:43]
    v_mfma_f32_16x16x32_bf16 v[40:43], v[36:39], v[76:79], v[40:43]
    v_mfma_f32_16x16x32_bf16 v[44:47], v[24:27], v[80:83], 0
    v_mfma_f32_16x16x32_bf16 v[44:47], v[28:31], v[84:87], v[44:47]
    v_mfma_f32_16x16x32_bf16 v[44:47], v[32:35], v[88:91], v[44:47]
    v_mfma_f32_16x16x32_bf16 v[44:47], v[36:39], v[92:95], v[44:47]
    v_mfma_f32_16x16x32_bf16 v[48:51], v[24:27], v[192:195], 0
    v_mfma_f32_16x16x32_bf16 v[48:51], v[28:31], v[196:199], v[48:51]
    v_mfma_f32_16x16x32_bf16 v[48:51], v[32:35], v[200:203], v[48:51]
    v_mfma_f32_16x16x32_bf16 v[48:51], v[36:39], v[204:207], v[48:51]
    v_bfi_b32 v40, v8, s96, v40
    v_bfi_b32 v41, v8, s97, v41
    v_bfi_b32 v42, v8, s98, v42
    v_bfi_b32 v43, v8, s99, v43
    buffer_store_dwordx4 v[40:43], v12, s[44:47], s48 offen sc1
    v_mfma_f32_16x16x32_bf16 v[52:55], v[24:27], v[208:211], 0
    v_mfma_f32_16x16x32_bf16 v[52:55], v[28:31], v[212:215], v[52:55]
    v_mfma_f32_16x16x32_bf16 v[52:55], v[32:35], v[216:219], v[52:55]
    v_mfma_f32_16x16x32_bf16 v[52:55], v[36:39], v[220:223], v[52:55]
    v_bfi_b32 v44, v8, s96, v44
    v_bfi_b32 v45, v8, s97, v45
    v_bfi_b32 v46, v8, s98, v46
    v_bfi_b32 v47, v8, s99, v47
    buffer_store_dwordx4 v[44:47], v12, s[44:47], s49 offen sc1
    s_mov_b32 exec_lo, 0xff00ff
    s_mov_b32 exec_hi, 0xff00ff
    v_bfi_b32 v48, v8, s96, v48
    v_bfi_b32 v49, v8, s97, v49
    v_bfi_b32 v50, v8, s98, v50
    v_bfi_b32 v51, v8, s99, v51
    buffer_store_dwordx4 v[48:51], v12, s[44:47], s50 offen sc1
    v_bfi_b32 v52, v8, s96, v52
    v_bfi_b32 v53, v8, s97, v53
    v_bfi_b32 v54, v8, s98, v54
    v_bfi_b32 v55, v8, s99, v55
    buffer_store_dwordx4 v[52:55], v12, s[44:47], s51 offen sc1
    s_mov_b64 exec, -1
    s_endpgm
L_comm:
    s_mov_b32 s44, s34
    s_mov_b32 s45, s35
    s_mov_b32 s46, 8388608
    s_mov_b32 s47, 0x20000
    s_mov_b32 s48, s8
    s_mov_b32 s49, s9
    s_mov_b32 s50, 4608
    s_mov_b32 s51, 0x20000
    s_cmp_lt_u32 s2, 96
    s_cbranch_scc0 L_c_nx
    v_mul_u32_u24 v5, 72, v0
    buffer_load_dwordx4 v[64:67], v5, s[48:51], 0 offen
    buffer_load_dwordx4 v[68:71], v5, s[48:51], 0 offen offset:16
    buffer_load_dwordx4 v[72:75], v5, s[48:51], 0 offen offset:32
    buffer_load_dwordx4 v[76:79], v5, s[48:51], 0 offen offset:48
    buffer_load_dwordx2 v[80:81], v5, s[48:51], 0 offen offset:64
L_c_nx:
    s_getreg_b32 s18, hwreg(HW_REG_XCC_ID, 0, 4)
    s_lshl_b32 s18, s18, 8
    v_mov_b32 v13, 0xff
    v_lshlrev_b32 v7, 2, v0
    v_and_b32 v6, 7, v0
    v_mul_u32_u24 v6, 144, v6
    v_lshrrev_b32 v5, 3, v0
    v_lshl_add_u32 v6, v5, 4, v6
    s_mul_i32 s58, s101, 3641
    s_mov_b32 s6, s101
    s_lshr_b32 s58, s58, 16
    s_mul_i32 s53, s58, 18
    s_sub_u32 s6, s6, s53
    s_lshl_b32 s53, s4, 2
    s_and_b32 s54, s5, 3
    s_add_u32 s53, s53, s54
    s_lshl_b32 s53, s53, 1
    s_lshr_b32 s54, s5, 2
    s_cmp_lt_u32 s2, 96
    s_cselect_b32 s53, s53, s6
    s_cselect_b32 s58, s54, s58
    s_waitcnt lgkmcnt(0)
    s_add_u32 s100, s100, 0x01010101
    s_bfe_u32 s96, s100, 0x80000
    s_bfe_u32 s97, s100, 0x80008
    s_bfe_u32 s98, s100, 0x80010
    s_bfe_u32 s99, s100, 0x80018
    s_or_b32 s52, s18, s96
    v_mov_b32 v8, s52
    s_or_b32 s52, s18, s97
    v_mov_b32 v9, s52
    s_or_b32 s52, s18, s98
    v_mov_b32 v10, s52
    s_or_b32 s52, s18, s99
    v_mov_b32 v11, s52
    s_lshl_b32 s52, s4, 5
    s_add_u32 s52, s52, s5
    s_lshl_b32 s52, s52, 4
    s_add_u32 s52, s52, 4096
    s_mov_b64 exec, 1
    buffer_store_dwordx4 v[8:11], v15, s[44:47], s52 offen sc1
    s_mov_b64 exec, -1
    s_cmp_lt_u32 s2, 96
    s_cbranch_scc1 L_c_q
    s_cmp_lt_u32 s101, 54
    s_cbranch_scc0 L_c_xf
    s_mul_i32 s55, s58, 18432
    s_lshl_b32 s53, s53, 10
    s_add_u32 s55, s55, s53
    s_add_u32 s55, s55, 8192
Lsp_120:
    ds_read_b32 v5, v15 offset:19016
    s_waitcnt lgkmcnt(0)
    v_cmp_gt_u32 vcc, 3, v5
    s_cbranch_vccnz Lsp_120
    ds_read_b128 v[16:19], v6 offset:21248
    ds_read_b128 v[20:23], v6 offset:22400
    ds_read_b128 v[24:27], v6 offset:23552
    ds_read_b128 v[28:31], v6 offset:24704
    ds_read_b128 v[32:35], v6 offset:25856
    ds_read_b128 v[36:39], v6 offset:27008
    s_waitcnt lgkmcnt(4)
    v_pk_add_f32 v[16:17], v[16:17], v[20:21]
    v_pk_add_f32 v[18:19], v[18:19], v[22:23]
    s_waitcnt lgkmcnt(3)
    v_pk_add_f32 v[16:17], v[16:17], v[24:25]
    v_pk_add_f32 v[18:19], v[18:19], v[26:27]
    s_waitcnt lgkmcnt(2)
    v_pk_add_f32 v[16:17], v[16:17], v[28:29]
    v_pk_add_f32 v[18:19], v[18:19], v[30:31]
    s_waitcnt lgkmcnt(1)
    v_pk_add_f32 v[16:17], v[16:17], v[32:33]
    v_pk_add_f32 v[18:19], v[18:19], v[34:35]
    s_waitcnt lgkmcnt(0)
    v_pk_add_f32 v[16:17], v[16:17], v[36:37]
    v_pk_add_f32 v[18:19], v[18:19], v[38:39]
    v_add_u32 v16, 0x80, v16
    v_add_u32 v17, 0x80, v17
    v_add_u32 v18, 0x80, v18
    v_add_u32 v19, 0x80, v19
    v_bfi_b32 v16, v13, s96, v16
    v_bfi_b32 v17, v13, s97, v17
    v_bfi_b32 v18, v13, s98, v18
    v_bfi_b32 v19, v13, s99, v19
    buffer_store_dwordx4 v[16:19], v1, s[44:47], s55 offen sc1
L_c_xf:
Lsp_121:
    s_sleep 4
    ds_read_b32 v5, v15 offset:19052
    s_waitcnt lgkmcnt(0)
    v_cmp_gt_u32 vcc, 4, v5
    s_cbranch_vccnz Lsp_121
    s_lshl_b32 s52, s4, 9
    s_add_u32 s52, s52, 4096
    s_mov_b32 exec_hi, 0
    s_mov_b32 s62, 400000
    s_branch Lp0_124
Lpo_122:
    s_sleep 4
    s_sub_u32 s62, s62, 1
    s_cbranch_scc1 Lpd_123
Lp0_124:
    buffer_load_dwordx4 v[8:11], v1, s[44:47], s52 offen sc1
    s_waitcnt vmcnt(0)
    v_xor_b32 v8, s96, v8
    v_xor_b32 v9, s97, v9
    v_xor_b32 v10, s98, v10
    v_xor_b32 v11, s99, v11
    v_or3_b32 v5, v8, v9, v10
    v_or_b32 v5, v5, v11
    v_and_b32 v5, 0xff, v5
    v_cmp_ne_u32 vcc, 0, v5
    s_cbranch_vccnz Lpo_122
Lpd_123:
    v_cmp_ne_u32 vcc, s18, v8
    s_mov_b64 exec, -1
    s_cmp_eq_u64 vcc, 0
    s_cselect_b32 s19, 2, 1
    s_sub_u32 s6, s5, 18
    s_cmp_lt_u32 s6, 9
    s_cbranch_scc0 L_c_gq
    s_lshl_b32 s52, s6, 7
    v_lshlrev_b32 v5, 1, v0
    buffer_load_ushort v40, v5, s[48:51], s52 offen offset:0
    buffer_load_ushort v41, v5, s[48:51], s52 offen offset:1152
    buffer_load_ushort v42, v5, s[48:51], s52 offen offset:2304
    buffer_load_ushort v43, v5, s[48:51], s52 offen offset:3456
    s_lshl_b32 s52, s6, 13
    s_add_u32 s56, s52, 593920
    s_lshl_b32 s52, s4, 31
    s_and_b32 s52, s52, 0xffff
    s_add_u32 s56, s56, s52
    s_mul_i32 s52, s4, 9216
    s_lshl_b32 s53, s6, 8
    s_add_u32 s52, s52, s53
    s_add_u32 s58, s52, 1183744
    s_add_u32 s59, s58, 4608
    v_lshlrev_b32 v5, 7, v0
    buffer_load_dword v250, v5, s[44:47], s56 offen sc1
    buffer_load_dword v250, v7, s[44:47], s58 offen offset:0 sc1
    buffer_load_dword v250, v7, s[44:47], s58 offen offset:2304 sc1
    buffer_load_dword v250, v7, s[44:47], s59 offen offset:0 sc1
    buffer_load_dword v250, v7, s[44:47], s59 offen offset:2304 sc1
    s_branch L_c_gq
L_c_q:
    s_waitcnt vmcnt(1)
    v_and_b32 v97, 0xffff0000, v64
    v_lshlrev_b32 v96, 16, v64
    v_and_b32 v99, 0xffff0000, v65
    v_lshlrev_b32 v98, 16, v65
    v_and_b32 v101, 0xffff0000, v66
    v_lshlrev_b32 v100, 16, v66
    v_and_b32 v103, 0xffff0000, v67
    v_lshlrev_b32 v102, 16, v67
    v_and_b32 v105, 0xffff0000, v68
    v_lshlrev_b32 v104, 16, v68
    v_and_b32 v107, 0xffff0000, v69
    v_lshlrev_b32 v106, 16, v69
    v_and_b32 v109, 0xffff0000, v70
    v_lshlrev_b32 v108, 16, v70
    v_and_b32 v111, 0xffff0000, v71
    v_lshlrev_b32 v110, 16, v71
    v_and_b32 v113, 0xffff0000, v72
    v_lshlrev_b32 v112, 16, v72
    v_and_b32 v115, 0xffff0000, v73
    v_lshlrev_b32 v114, 16, v73
    v_and_b32 v117, 0xffff0000, v74
    v_lshlrev_b32 v116, 16, v74
    v_and_b32 v119, 0xffff0000, v75
    v_lshlrev_b32 v118, 16, v75
    v_and_b32 v121, 0xffff0000, v76
    v_lshlrev_b32 v120, 16, v76
    v_and_b32 v123, 0xffff0000, v77
    v_lshlrev_b32 v122, 16, v77
    v_and_b32 v125, 0xffff0000, v78
    v_lshlrev_b32 v124, 16, v78
    v_and_b32 v127, 0xffff0000, v79
    v_lshlrev_b32 v126, 16, v79
    v_and_b32 v129, 0xffff0000, v80
    v_lshlrev_b32 v128, 16, v80
    v_and_b32 v131, 0xffff0000, v81
    v_lshlrev_b32 v130, 16, v81
    v_pk_add_f32 v[16:17], v[96:97], v[98:99]
    v_pk_mul_f32 v[18:19], v[96:97], v[96:97]
    v_pk_fma_f32 v[18:19], v[98:99], v[98:99], v[18:19]
    v_pk_add_f32 v[16:17], v[16:17], v[100:101]
    v_pk_fma_f32 v[18:19], v[100:101], v[100:101], v[18:19]
    v_pk_add_f32 v[16:17], v[16:17], v[102:103]
    v_pk_fma_f32 v[18:19], v[102:103], v[102:103], v[18:19]
    v_pk_add_f32 v[16:17], v[16:17], v[104:105]
    v_pk_fma_f32 v[18:19], v[104:105], v[104:105], v[18:19]
    v_pk_add_f32 v[16:17], v[16:17], v[106:107]
    v_pk_fma_f32 v[18:19], v[106:107], v[106:107], v[18:19]
    v_pk_add_f32 v[16:17], v[16:17], v[108:109]
    v_pk_fma_f32 v[18:19], v[108:109], v[108:109], v[18:19]
    v_pk_add_f32 v[16:17], v[16:17], v[110:111]
    v_pk_fma_f32 v[18:19], v[110:111], v[110:111], v[18:19]
    v_pk_add_f32 v[16:17], v[16:17], v[112:113]
    v_pk_fma_f32 v[18:19], v[112:113], v[112:113], v[18:19]
    v_pk_add_f32 v[16:17], v[16:17], v[114:115]
    v_pk_fma_f32 v[18:19], v[114:115], v[114:115], v[18:19]
    v_pk_add_f32 v[16:17], v[16:17], v[116:117]
    v_pk_fma_f32 v[18:19], v[116:117], v[116:117], v[18:19]
    v_pk_add_f32 v[16:17], v[16:17], v[118:119]
    v_pk_fma_f32 v[18:19], v[118:119], v[118:119], v[18:19]
    v_pk_add_f32 v[16:17], v[16:17], v[120:121]
    v_pk_fma_f32 v[18:19], v[120:121], v[120:121], v[18:19]
    v_pk_add_f32 v[16:17], v[16:17], v[122:123]
    v_pk_fma_f32 v[18:19], v[122:123], v[122:123], v[18:19]
    v_pk_add_f32 v[16:17], v[16:17], v[124:125]
    v_pk_fma_f32 v[18:19], v[124:125], v[124:125], v[18:19]
    v_pk_add_f32 v[16:17], v[16:17], v[126:127]
    v_pk_fma_f32 v[18:19], v[126:127], v[126:127], v[18:19]
    v_pk_add_f32 v[16:17], v[16:17], v[128:129]
    v_pk_fma_f32 v[18:19], v[128:129], v[128:129], v[18:19]
    v_pk_add_f32 v[16:17], v[16:17], v[130:131]
    v_pk_fma_f32 v[18:19], v[130:131], v[130:131], v[18:19]
    v_add_f32 v16, v16, v17
    v_add_f32 v18, v18, v19
    s_nop 0
    v_add_f32_dpp v16, v16, v16 row_ror:1 row_mask:0xf bank_mask:0xf
    v_add_f32_dpp v18, v18, v18 row_ror:1 row_mask:0xf bank_mask:0xf
    s_nop 0
    v_add_f32_dpp v16, v16, v16 row_ror:2 row_mask:0xf bank_mask:0xf
    v_add_f32_dpp v18, v18, v18 row_ror:2 row_mask:0xf bank_mask:0xf
    s_nop 0
    v_add_f32_dpp v16, v16, v16 row_ror:4 row_mask:0xf bank_mask:0xf
    v_add_f32_dpp v18, v18, v18 row_ror:4 row_mask:0xf bank_mask:0xf
    s_nop 0
    v_add_f32_dpp v16, v16, v16 row_ror:8 row_mask:0xf bank_mask:0xf
    v_add_f32_dpp v18, v18, v18 row_ror:8 row_mask:0xf bank_mask:0xf
    v_mul_f32 v16, 0x3ae38e39, v16
    v_mul_f32 v18, 0x3ae38e39, v18
    v_fma_f32 v18, -v16, v16, v18
    v_max_f32 v18, 0, v18
    v_cvt_pk_bf16_f32 v17, v16, v18
    v_and_b32 v18, 0xffff0000, v17
    v_lshlrev_b32 v16, 16, v17
    v_add_f32 v18, 0x3727c5ac, v18
    v_cvt_pk_bf16_f32 v18, v18, v18
    v_lshlrev_b32 v18, 16, v18
    v_sqrt_f32 v18, v18
    v_lshrrev_b32 v5, 4, v0
    v_cvt_pk_bf16_f32 v18, v18, v18
    v_lshlrev_b32 v18, 16, v18
    v_rcp_f32 v18, v18
    v_lshlrev_b32 v5, 2, v5
    s_mov_b32 exec_lo, 0x00010001
    s_mov_b32 exec_hi, 0x00010001
    ds_write_b32 v5, v16 offset:19104
    ds_write_b32 v5, v18 offset:19120
    s_mov_b64 exec, 1
    ds_add_u32 v15, v14 offset:19044
    s_mov_b64 exec, -1
    s_lshl_b32 s55, s58, 16
    s_lshl_b32 s53, s53, 8
    s_add_u32 s55, s55, s53
    s_add_u32 s55, s55, 65536
    v_lshrrev_b32 v5, 4, v0
    v_lshlrev_b32 v5, 14, v5
    v_and_b32 v12, 15, v0
    v_lshl_add_u32 v12, v12, 4, v5
    s_waitcnt vmcnt(0)
    s_lshl_b32 s52, s4, 9
    s_add_u32 s52, s52, 4096
    s_mov_b32 exec_hi, 0
    s_mov_b32 s62, 400000
    s_branch Lp0_127
Lpo_125:
    s_sleep 4
    s_sub_u32 s62, s62, 1
    s_cbranch_scc1 Lpd_126
Lp0_127:
    buffer_load_dwordx4 v[8:11], v1, s[44:47], s52 offen sc1
    s_waitcnt vmcnt(0)
    v_xor_b32 v8, s96, v8
    v_xor_b32 v9, s97, v9
    v_xor_b32 v10, s98, v10
    v_xor_b32 v11, s99, v11
    v_or3_b32 v5, v8, v9, v10
    v_or_b32 v5, v5, v11
    v_and_b32 v5, 0xff, v5
    v_cmp_ne_u32 vcc, 0, v5
    s_cbranch_vccnz Lpo_125
Lpd_126:
    v_cmp_ne_u32 vcc, s18, v8
    s_mov_b64 exec, -1
    s_cmp_eq_u64 vcc, 0
    s_cselect_b32 s19, 2, 1
    s_lshr_b32 s52, s5, 4
    s_lshl_b32 s53, s4, 1
    s_add_u32 s52, s52, s53
    s_lshl_b32 s52, s52, 10
    s_bfe_u32 s53, s5, 0x20002
    s_lshl_b32 s53, s53, 14
    s_add_u32 s52, s52, s53
    s_add_u32 s52, s52, 65536
    s_add_u32 s53, s52, 65536
    s_add_u32 s54, s52, 131072
    v_lshlrev_b32 v5, 7, v0
    s_mov_b32 exec_lo, 0xff
    s_mov_b32 exec_hi, 0
    buffer_load_dword v250, v5, s[44:47], s52 offen sc1
    buffer_load_dword v250, v5, s[44:47], s53 offen sc1
    buffer_load_dword v250, v5, s[44:47], s54 offen sc1
    s_mov_b64 exec, -1
Lsp_128:
    ds_read_b32 v5, v15 offset:19016
    s_waitcnt lgkmcnt(0)
    v_cmp_gt_u32 vcc, 3, v5
    s_cbranch_vccnz Lsp_128
    ds_read_b128 v[16:19], v6 offset:21248
    ds_read_b128 v[20:23], v6 offset:22400
    ds_read_b128 v[24:27], v6 offset:23552
    ds_read_b128 v[28:31], v6 offset:24704
    ds_read_b128 v[32:35], v6 offset:25856
    ds_read_b128 v[36:39], v6 offset:27008
    ds_read_b128 v[40:43], v6 offset:28160
    ds_read_b128 v[44:47], v6 offset:29312
    ds_read_b128 v[48:51], v6 offset:30464
    ds_read_b128 v[52:55], v6 offset:31616
    ds_read_b128 v[56:59], v6 offset:32768
    ds_read_b128 v[60:63], v6 offset:33920
    s_waitcnt lgkmcnt(6)
    v_pk_add_f32 v[16:17], v[16:17], v[20:21]
    v_pk_add_f32 v[18:19], v[18:19], v[22:23]
    v_pk_add_f32 v[24:25], v[24:25], v[28:29]
    v_pk_add_f32 v[26:27], v[26:27], v[30:31]
    v_pk_add_f32 v[32:33], v[32:33], v[36:37]
    v_pk_add_f32 v[34:35], v[34:35], v[38:39]
    v_pk_add_f32 v[16:17], v[16:17], v[24:25]
    v_pk_add_f32 v[18:19], v[18:19], v[26:27]
    v_pk_add_f32 v[16:17], v[16:17], v[32:33]
    v_pk_add_f32 v[18:19], v[18:19], v[34:35]
    ds_write_b32 v7, v16 offset:16448
    ds_write_b32 v7, v17 offset:16704
    ds_write_b32 v7, v18 offset:16960
    ds_write_b32 v7, v19 offset:17216
    s_waitcnt lgkmcnt(4)
    v_pk_add_f32 v[40:41], v[40:41], v[44:45]
    v_pk_add_f32 v[42:43], v[42:43], v[46:47]
    v_pk_add_f32 v[48:49], v[48:49], v[52:53]
    v_pk_add_f32 v[50:51], v[50:51], v[54:55]
    v_pk_add_f32 v[56:57], v[56:57], v[60:61]
    v_pk_add_f32 v[58:59], v[58:59], v[62:63]
    v_pk_add_f32 v[40:41], v[40:41], v[48:49]
    v_pk_add_f32 v[42:43], v[42:43], v[50:51]
    v_pk_add_f32 v[40:41], v[40:41], v[56:57]
    v_pk_add_f32 v[42:43], v[42:43], v[58:59]
    ds_write_b32 v7, v40 offset:17472
    ds_write_b32 v7, v41 offset:17728
    ds_write_b32 v7, v42 offset:17984
    ds_write_b32 v7, v43 offset:18240
    ds_read_b128 v[16:19], v1 offset:16448
    ds_read_b128 v[20:23], v1 offset:17472
    s_cmp_eq_u32 s19, 2
    s_waitcnt lgkmcnt(0)
    v_add_u32 v16, 0x80, v16
    v_add_u32 v17, 0x80, v17
    v_add_u32 v18, 0x80, v18
    v_add_u32 v19, 0x80, v19
    v_bfi_b32 v16, v13, s96, v16
    v_bfi_b32 v17, v13, s97, v17
    v_bfi_b32 v18, v13, s98, v18
    v_bfi_b32 v19, v13, s99, v19
    v_add_u32 v20, 0x80, v20
    v_add_u32 v21, 0x80, v21
    v_add_u32 v22, 0x80, v22
    v_add_u32 v23, 0x80, v23
    v_bfi_b32 v20, v13, s96, v20
    v_bfi_b32 v21, v13, s97, v21
    v_bfi_b32 v22, v13, s98, v22
    v_bfi_b32 v23, v13, s99, v23
    s_cbranch_scc1 L_qp_loc
    buffer_store_dwordx4 v[16:19], v12, s[44:47], s55 offen sc1
    buffer_store_dwordx4 v[20:23], v12, s[44:47], s55 offen offset:256 sc1
    s_branch L_qp_done
L_qp_loc:
    buffer_store_dwordx4 v[16:19], v12, s[44:47], s55 offen
    buffer_store_dwordx4 v[20:23], v12, s[44:47], s55 offen offset:256
L_qp_done:
L_c_gq:
    v_lshlrev_b32 v5, 7, v0
    s_lshl_b32 s52, s4, 5
    s_add_u32 s52, s52, s5
    s_lshl_b32 s53, s52, 7
    s_add_u32 s53, s53, 299008
    s_lshl_b32 s52, s52, 10
    s_add_u32 s52, s52, 331776
    s_mov_b32 exec_lo, 0xff
    s_mov_b32 exec_hi, 0
    buffer_load_dword v250, v5, s[44:47], s52 offen sc1
    s_mov_b64 exec, 1
    buffer_load_dword v250, v5, s[44:47], s53 offen sc1
    s_mov_b64 exec, -1
    s_lshr_b32 s52, s5, 4
    s_lshl_b32 s53, s4, 1
    s_add_u32 s52, s52, s53
    s_lshl_b32 s52, s52, 10
    s_bfe_u32 s53, s5, 0x20002
    s_lshl_b32 s53, s53, 14
    s_add_u32 s52, s52, s53
    s_add_u32 s52, s52, 65536
    s_add_u32 s53, s52, 65536
    s_add_u32 s54, s52, 131072
    v_lshlrev_b32 v8, 3, v0
    s_and_b32 s55, s5, 1
    s_lshl_b32 s55, s55, 7
    s_add_u32 s55, s55, s52
    s_add_u32 s40, s34, s55
    s_addc_u32 s41, s35, 0
    v_mov_b32 v9, s19
    s_mov_b32 s62, 400000
    buffer_load_dwordx4 v[24:27], v1, s[44:47], s52 offen sc1
    buffer_load_dwordx4 v[28:31], v1, s[44:47], s53 offen sc1
    buffer_load_dwordx4 v[32:35], v1, s[44:47], s54 offen sc1
    s_sleep 12
L_qp_l:
    buffer_load_dwordx4 v[96:99], v1, s[44:47], s52 offen sc1
    buffer_load_dwordx4 v[100:103], v1, s[44:47], s53 offen sc1
    buffer_load_dwordx4 v[104:107], v1, s[44:47], s54 offen sc1
    s_waitcnt vmcnt(3)
    v_xor_b32 v24, s96, v24
    v_xor_b32 v25, s97, v25
    v_xor_b32 v26, s98, v26
    v_xor_b32 v27, s99, v27
    v_xor_b32 v28, s96, v28
    v_xor_b32 v29, s97, v29
    v_xor_b32 v30, s98, v30
    v_xor_b32 v31, s99, v31
    v_xor_b32 v32, s96, v32
    v_xor_b32 v33, s97, v33
    v_xor_b32 v34, s98, v34
    v_xor_b32 v35, s99, v35
    v_or3_b32 v5, v24, v25, v26
    v_or3_b32 v5, v5, v27, v28
    v_or3_b32 v5, v5, v29, v30
    v_or3_b32 v5, v5, v31, v32
    v_or3_b32 v5, v5, v33, v34
    v_bitop3_b32 v5, v5, v35, v13 bitop3:0xa8
    v_pk_add_f32 v[24:25], v[24:25], v[28:29]
    v_pk_add_f32 v[26:27], v[26:27], v[30:31]
    v_pk_add_f32 v[20:21], v[24:25], v[32:33]
    v_pk_add_f32 v[22:23], v[26:27], v[34:35]
    v_cmp_ne_u32 vcc, 0, v5
    s_cbranch_vccz L_qp_d
    buffer_load_dwordx4 v[24:27], v1, s[44:47], s52 offen sc1
    buffer_load_dwordx4 v[28:31], v1, s[44:47], s53 offen sc1
    buffer_load_dwordx4 v[32:35], v1, s[44:47], s54 offen sc1
    s_waitcnt vmcnt(3)
    v_xor_b32 v96, s96, v96
    v_xor_b32 v97, s97, v97
    v_xor_b32 v98, s98, v98
    v_xor_b32 v99, s99, v99
    v_xor_b32 v100, s96, v100
    v_xor_b32 v101, s97, v101
    v_xor_b32 v102, s98, v102
    v_xor_b32 v103, s99, v103
    v_xor_b32 v104, s96, v104
    v_xor_b32 v105, s97, v105
    v_xor_b32 v106, s98, v106
    v_xor_b32 v107, s99, v107
    v_or3_b32 v5, v96, v97, v98
    v_or3_b32 v5, v5, v99, v100
    v_or3_b32 v5, v5, v101, v102
    v_or3_b32 v5, v5, v103, v104
    v_or3_b32 v5, v5, v105, v106
    v_bitop3_b32 v5, v5, v107, v13 bitop3:0xa8
    v_pk_add_f32 v[96:97], v[96:97], v[100:101]
    v_pk_add_f32 v[98:99], v[98:99], v[102:103]
    v_pk_add_f32 v[20:21], v[96:97], v[104:105]
    v_pk_add_f32 v[22:23], v[98:99], v[106:107]
    v_cmp_ne_u32 vcc, 0, v5
    s_sub_u32 s62, s62, 1
    s_cbranch_scc1 L_qp_d
    s_cbranch_vccnz L_qp_l
L_qp_d:
    v_cvt_pk_bf16_f32 v20, v20, v21
    v_cvt_pk_bf16_f32 v21, v22, v23
    ds_write_b64 v8, v[20:21] offset:19136
    s_mov_b64 exec, 1
    ds_write_b32 v15, v9 offset:19048
    s_mov_b64 exec, -1
    s_mov_b32 s36, s20
    s_mov_b32 s37, s21
    s_mov_b32 s38, 5308416
    s_mov_b32 s39, 0x20000
    s_mov_b32 s40, s22
    s_mov_b32 s41, s23
    s_mov_b32 s42, 5308416
    s_mov_b32 s43, 0x20000
    s_mul_i32 s52, s4, 1152
    s_lshr_b32 s53, s20, 7
    s_add_u32 s53, s53, s4
    s_sub_u32 s53, 3, s53
    s_and_b32 s53, s53, 7
    s_cmp_eq_u32 s53, 0
    s_cselect_b32 s54, 15, 0
    s_lshl_b32 s53, s53, 7
    s_add_u32 s53, s53, s52
    v_mul_u32_u24 v200, 3641, v0
    v_lshrrev_b32 v200, 16, v200
    v_mul_u32_u24 v201, 18, v200
    v_sub_u32 v201, v0, v201
    s_mul_i32 s55, s5, 18
    v_add_u32 v201, s55, v201
    v_mul_u32_u24 v201, 9216, v201
    v_lshl_add_u32 v201, v200, 10, v201
    v_mul_u32_u24 v200, 7282, v0
    v_lshrrev_b32 v200, 16, v200
    v_mul_u32_u24 v202, 9, v200
    v_sub_u32 v202, v0, v202
    s_mul_i32 s55, s5, 6
    v_add_u32 v200, s55, v200
    v_lshrrev_b32 v203, 6, v200
    v_lshl_add_u32 v200, v203, 7, v200
    v_add_u32 v200, 128, v200
    v_mul_u32_u24 v200, 9216, v200
    v_lshl_add_u32 v202, v202, 7, v200
Lsp_129:
    s_sleep 1
    ds_read_b32 v5, v15 offset:19020
    s_waitcnt lgkmcnt(0)
    v_cmp_gt_u32 vcc, 8, v5
    s_cbranch_vccnz Lsp_129
    s_cmp_eq_u32 s54, 0
    s_cselect_b32 exec_lo, 0x3ffff, -1
    s_mov_b32 exec_hi, s54
    buffer_load_dword v250, v201, s[36:39], s53 offen
    buffer_load_dword v250, v201, s[40:43], s53 offen
    s_mov_b32 exec_lo, -1
    s_mov_b32 exec_hi, 0x3fffff
    buffer_load_dword v250, v202, s[36:39], s52 offen
    buffer_load_dword v250, v202, s[40:43], s52 offen
    s_mov_b64 exec, -1
    s_cmp_lt_u32 s2, 144
    s_cbranch_scc1 L_end
    s_waitcnt vmcnt(0)
    s_cmp_lt_u32 s2, 216
    s_cbranch_scc1 L_c_wo
    s_cmp_lt_u32 s2, 252
    s_cbranch_scc0 L_end
    s_sub_u32 s6, s2, 216
    s_mul_i32 s52, s6, 7282
    s_lshr_b32 s52, s52, 16
    s_mul_i32 s53, s52, 9
    s_sub_u32 s53, s6, s53
    s_mul_i32 s55, s52, 9216
    s_lshl_b32 s53, s53, 8
    s_add_u32 s55, s55, s53
    s_add_u32 s55, s55, 262144
    v_lshrrev_b32 v5, 4, v0
    v_mul_u32_u24 v5, 2304, v5
    v_and_b32 v12, 15, v0
    v_lshl_add_u32 v12, v12, 4, v5
Lsp_130:
    s_sleep 1
    ds_read_b32 v5, v15 offset:19012
    s_waitcnt lgkmcnt(0)
    v_cmp_gt_u32 vcc, 3, v5
    s_cbranch_vccnz Lsp_130
    ds_read_b128 v[16:19], v6 offset:4672
    ds_read_b128 v[20:23], v6 offset:5824
    ds_read_b128 v[24:27], v6 offset:6976
    ds_read_b128 v[28:31], v6 offset:8128
    ds_read_b128 v[32:35], v6 offset:9280
    ds_read_b128 v[36:39], v6 offset:10432
    s_waitcnt lgkmcnt(4)
    v_pk_add_f32 v[16:17], v[16:17], v[20:21]
    v_pk_add_f32 v[18:19], v[18:19], v[22:23]
    s_waitcnt lgkmcnt(3)
    v_pk_add_f32 v[16:17], v[16:17], v[24:25]
    v_pk_add_f32 v[18:19], v[18:19], v[26:27]
    s_waitcnt lgkmcnt(2)
    v_pk_add_f32 v[16:17], v[16:17], v[28:29]
    v_pk_add_f32 v[18:19], v[18:19], v[30:31]
    s_waitcnt lgkmcnt(1)
    v_pk_add_f32 v[16:17], v[16:17], v[32:33]
    v_pk_add_f32 v[18:19], v[18:19], v[34:35]
    s_waitcnt lgkmcnt(0)
    v_pk_add_f32 v[16:17], v[16:17], v[36:37]
    v_pk_add_f32 v[18:19], v[18:19], v[38:39]
    v_cvt_pk_bf16_f32 v20, v16, v17
    v_cvt_pk_bf16_f32 v21, v18, v19
    v_and_b32 v17, 0xffff0000, v20
    v_lshlrev_b32 v16, 16, v20
    v_and_b32 v19, 0xffff0000, v21
    v_lshlrev_b32 v18, 16, v21
    ds_write_b32 v7, v16 offset:16448
    ds_write_b32 v7, v17 offset:16704
    ds_write_b32 v7, v18 offset:16960
    ds_write_b32 v7, v19 offset:17216
    ds_read_b128 v[16:19], v1 offset:16448
    s_waitcnt lgkmcnt(0)
    v_bfi_b32 v16, v13, s96, v16
    v_bfi_b32 v17, v13, s97, v17
    v_bfi_b32 v18, v13, s98, v18
    v_bfi_b32 v19, v13, s99, v19
    buffer_store_dwordx4 v[16:19], v12, s[44:47], s55 offen sc1
    s_endpgm
L_c_wo:
    s_sub_u32 s6, s5, 18
    s_lshl_b32 s52, s6, 7
    v_lshlrev_b32 v5, 1, v0
    v_and_b32 v12, 3, v0
    v_lshlrev_b32 v12, 3, v12
    v_lshrrev_b32 v12, v12, s100
    v_and_b32 v12, 0xff, v12
    s_lshl_b32 s53, s6, 8
    s_add_u32 s56, s53, 262144
    s_add_u32 s57, s56, 4608
    s_add_u32 s58, s53, 289792
    s_add_u32 s59, s58, 4608
    s_mov_b32 s24, s56
    s_mov_b32 s25, s57
    v_lshlrev_b32 v40, 16, v40
    v_lshlrev_b32 v41, 16, v41
    v_lshlrev_b32 v42, 16, v42
    v_lshlrev_b32 v43, 16, v43
    s_lshl_b32 s52, s6, 13
    s_add_u32 s56, s52, 593920
    s_lshl_b32 s52, s4, 10
    s_add_u32 s55, s56, s52
    s_lshl_b32 s52, s4, 31
    s_and_b32 s52, s52, 0xffff
    s_add_u32 s56, s56, s52
    s_add_u32 s57, s56, 4096
    s_mul_i32 s52, s4, 9216
    s_lshl_b32 s53, s6, 8
    s_add_u32 s52, s52, s53
    s_add_u32 s58, s52, 1183744
    s_add_u32 s59, s58, 4608
    v_and_b32 v9, 7, v0
    v_lshlrev_b32 v9, 3, v9
    v_add_u32 v9, s4, v9
    v_lshrrev_b32 v10, 4, v0
    v_lshlrev_b32 v11, 4, v9
    v_lshl_add_u32 v11, v10, 2, v11
    v_mul_u32_u24 v10, 1152, v10
    v_lshl_add_u32 v10, v9, 1, v10
Lsp_131:
    ds_read_b32 v5, v15 offset:19012
    s_waitcnt lgkmcnt(0)
    v_cmp_gt_u32 vcc, 3, v5
    s_cbranch_vccnz Lsp_131
    ds_read_b128 v[16:19], v6 offset:4672
    ds_read_b128 v[20:23], v6 offset:5824
    ds_read_b128 v[24:27], v6 offset:6976
    ds_read_b128 v[28:31], v6 offset:8128
    ds_read_b128 v[32:35], v6 offset:9280
    ds_read_b128 v[36:39], v6 offset:10432
    s_waitcnt lgkmcnt(4)
    v_pk_add_f32 v[16:17], v[16:17], v[20:21]
    v_pk_add_f32 v[18:19], v[18:19], v[22:23]
    s_waitcnt lgkmcnt(3)
    v_pk_add_f32 v[16:17], v[16:17], v[24:25]
    v_pk_add_f32 v[18:19], v[18:19], v[26:27]
    s_waitcnt lgkmcnt(2)
    v_pk_add_f32 v[16:17], v[16:17], v[28:29]
    v_pk_add_f32 v[18:19], v[18:19], v[30:31]
    s_waitcnt lgkmcnt(1)
    v_pk_add_f32 v[16:17], v[16:17], v[32:33]
    v_pk_add_f32 v[18:19], v[18:19], v[34:35]
    s_waitcnt lgkmcnt(0)
    v_pk_add_f32 v[16:17], v[16:17], v[36:37]
    v_pk_add_f32 v[18:19], v[18:19], v[38:39]
    v_bfi_b32 v16, v13, s96, v16
    v_bfi_b32 v17, v13, s97, v17
    v_bfi_b32 v18, v13, s98, v18
    v_bfi_b32 v19, v13, s99, v19
    buffer_store_dwordx4 v[16:19], v1, s[44:47], s55 offen sc1
    buffer_load_dword v44, v7, s[44:47], s24 offen offset:0 sc1
    buffer_load_dword v45, v7, s[44:47], s24 offen offset:2304 sc1
    buffer_load_dword v46, v7, s[44:47], s25 offen offset:0 sc1
    buffer_load_dword v47, v7, s[44:47], s25 offen offset:2304 sc1
    s_mov_b32 s62, 400000
Lpo_132:
    s_sub_u32 s62, s62, 1
    s_cbranch_scc1 Lpd_133
    buffer_load_dwordx4 v[64:67], v1, s[44:47], s56 offen offset:0 sc1
    buffer_load_dwordx4 v[68:71], v1, s[44:47], s56 offen offset:1024 sc1
    buffer_load_dwordx4 v[72:75], v1, s[44:47], s56 offen offset:2048 sc1
    buffer_load_dwordx4 v[76:79], v1, s[44:47], s56 offen offset:3072 sc1
    buffer_load_dwordx4 v[80:83], v1, s[44:47], s57 offen offset:0 sc1
    buffer_load_dwordx4 v[84:87], v1, s[44:47], s57 offen offset:1024 sc1
    buffer_load_dwordx4 v[88:91], v1, s[44:47], s57 offen offset:2048 sc1
    buffer_load_dwordx4 v[92:95], v1, s[44:47], s57 offen offset:3072 sc1
    s_waitcnt vmcnt(7)
    v_xor_b32 v64, s96, v64
    v_xor_b32 v65, s97, v65
    v_xor_b32 v66, s98, v66
    v_xor_b32 v67, s99, v67
    v_or3_b32 v5, v64, v65, v66
    v_or_b32 v5, v5, v67
    s_waitcnt vmcnt(6)
    v_xor_b32 v68, s96, v68
    v_xor_b32 v69, s97, v69
    v_xor_b32 v70, s98, v70
    v_xor_b32 v71, s99, v71
    v_or3_b32 v5, v5, v68, v69
    v_or3_b32 v5, v5, v70, v71
    s_waitcnt vmcnt(5)
    v_xor_b32 v72, s96, v72
    v_xor_b32 v73, s97, v73
    v_xor_b32 v74, s98, v74
    v_xor_b32 v75, s99, v75
    v_or3_b32 v5, v5, v72, v73
    v_or3_b32 v5, v5, v74, v75
    s_waitcnt vmcnt(4)
    v_xor_b32 v76, s96, v76
    v_xor_b32 v77, s97, v77
    v_xor_b32 v78, s98, v78
    v_xor_b32 v79, s99, v79
    v_or3_b32 v5, v5, v76, v77
    v_or3_b32 v5, v5, v78, v79
    s_waitcnt vmcnt(3)
    v_xor_b32 v80, s96, v80
    v_xor_b32 v81, s97, v81
    v_xor_b32 v82, s98, v82
    v_xor_b32 v83, s99, v83
    v_or3_b32 v5, v5, v80, v81
    v_or3_b32 v5, v5, v82, v83
    s_waitcnt vmcnt(2)
    v_xor_b32 v84, s96, v84
    v_xor_b32 v85, s97, v85
    v_xor_b32 v86, s98, v86
    v_xor_b32 v87, s99, v87
    v_or3_b32 v5, v5, v84, v85
    v_or3_b32 v5, v5, v86, v87
    s_waitcnt vmcnt(1)
    v_xor_b32 v88, s96, v88
    v_xor_b32 v89, s97, v89
    v_xor_b32 v90, s98, v90
    v_xor_b32 v91, s99, v91
    v_or3_b32 v5, v5, v88, v89
    v_or3_b32 v5, v5, v90, v91
    s_waitcnt vmcnt(0)
    v_xor_b32 v92, s96, v92
    v_xor_b32 v93, s97, v93
    v_xor_b32 v94, s98, v94
    v_xor_b32 v95, s99, v95
    v_or3_b32 v5, v5, v92, v93
    v_or3_b32 v5, v5, v94, v95
    v_and_b32 v5, 0xff, v5
    v_cmp_ne_u32 vcc, 0, v5
    s_cbranch_vccnz Lpo_132
Lpd_133:
    v_pk_add_f32 v[64:65], v[64:65], v[68:69]
    v_pk_add_f32 v[66:67], v[66:67], v[70:71]
    v_pk_add_f32 v[72:73], v[72:73], v[76:77]
    v_pk_add_f32 v[74:75], v[74:75], v[78:79]
    v_pk_add_f32 v[80:81], v[80:81], v[84:85]
    v_pk_add_f32 v[82:83], v[82:83], v[86:87]
    v_pk_add_f32 v[88:89], v[88:89], v[92:93]
    v_pk_add_f32 v[90:91], v[90:91], v[94:95]
    v_pk_add_f32 v[64:65], v[64:65], v[72:73]
    v_pk_add_f32 v[66:67], v[66:67], v[74:75]
    v_pk_add_f32 v[80:81], v[80:81], v[88:89]
    v_pk_add_f32 v[82:83], v[82:83], v[90:91]
    v_pk_add_f32 v[20:21], v[64:65], v[80:81]
    v_pk_add_f32 v[22:23], v[66:67], v[82:83]
    s_mov_b32 s62, 400000
    s_branch Lp0_137
Lpo_135:
    s_sleep 1
    s_sub_u32 s62, s62, 1
    s_cbranch_scc1 Lpd_136
    buffer_load_dword v44, v7, s[44:47], s24 offen offset:0 sc1
    buffer_load_dword v45, v7, s[44:47], s24 offen offset:2304 sc1
    buffer_load_dword v46, v7, s[44:47], s25 offen offset:0 sc1
    buffer_load_dword v47, v7, s[44:47], s25 offen offset:2304 sc1
Lp0_137:
    s_waitcnt vmcnt(3)
    v_xor_b32 v44, v12, v44
    v_mov_b32 v9, v44
    s_waitcnt vmcnt(2)
    v_xor_b32 v45, v12, v45
    v_or_b32 v9, v9, v45
    s_waitcnt vmcnt(1)
    v_xor_b32 v46, v12, v46
    v_or_b32 v9, v9, v46
    s_waitcnt vmcnt(0)
    v_xor_b32 v47, v12, v47
    v_or_b32 v9, v9, v47
    v_and_b32 v9, 0xff, v9
    v_cmp_ne_u32 vcc, 0, v9
    s_cbranch_vccnz Lpo_135
Lpd_136:
    v_cvt_pk_bf16_f32 v24, v20, v21
    v_cvt_pk_bf16_f32 v25, v22, v23
    v_and_b32 v21, 0xffff0000, v24
    v_lshlrev_b32 v20, 16, v24
    v_and_b32 v23, 0xffff0000, v25
    v_lshlrev_b32 v22, 16, v25
    v_pk_mul_f32 v[20:21], v[20:21], v[44:45]
    v_pk_mul_f32 v[22:23], v[22:23], v[46:47]
    v_cvt_pk_bf16_f32 v24, v20, v21
    v_cvt_pk_bf16_f32 v25, v22, v23
    v_and_b32 v21, 0xffff0000, v24
    v_lshlrev_b32 v20, 16, v24
    v_and_b32 v23, 0xffff0000, v25
    v_lshlrev_b32 v22, 16, v25
    v_pk_add_f32 v[20:21], v[20:21], v[40:41]
    v_pk_add_f32 v[22:23], v[22:23], v[42:43]
    v_cvt_pk_bf16_f32 v24, v20, v21
    v_cvt_pk_bf16_f32 v25, v22, v23
    v_and_b32 v21, 0xffff0000, v24
    v_lshlrev_b32 v20, 16, v24
    v_and_b32 v23, 0xffff0000, v25
    v_lshlrev_b32 v22, 16, v25
    v_or_b32 v24, v12, v20
    v_or_b32 v25, v12, v21
    v_or_b32 v26, v12, v22
    v_or_b32 v27, v12, v23
    s_cmp_eq_u32 s19, 2
    s_cbranch_scc1 L_x1_loc
    buffer_store_dword v24, v7, s[44:47], s58 offen offset:0 sc1
    buffer_store_dword v25, v7, s[44:47], s58 offen offset:2304 sc1
    buffer_store_dword v26, v7, s[44:47], s59 offen offset:0 sc1
    buffer_store_dword v27, v7, s[44:47], s59 offen offset:2304 sc1
    s_branch L_x1_done
L_x1_loc:
    buffer_store_dword v24, v7, s[44:47], s58 offen offset:0
    buffer_store_dword v25, v7, s[44:47], s58 offen offset:2304
    buffer_store_dword v26, v7, s[44:47], s59 offen offset:0
    buffer_store_dword v27, v7, s[44:47], s59 offen offset:2304
L_x1_done:
    s_lshl_b32 s53, s6, 8
    s_add_u32 s58, s53, 289792
    s_add_u32 s59, s58, 4608
    s_mov_b32 s62, 400000
    s_branch Lp0_140
Lpo_138:
    s_sleep 4
    s_sub_u32 s62, s62, 1
    s_cbranch_scc1 Lpd_139
Lp0_140:
    buffer_load_dword v48, v7, s[44:47], s58 offen offset:0 sc1
    buffer_load_dword v49, v7, s[44:47], s58 offen offset:2304 sc1
    buffer_load_dword v50, v7, s[44:47], s59 offen offset:0 sc1
    buffer_load_dword v51, v7, s[44:47], s59 offen offset:2304 sc1
    s_waitcnt vmcnt(3)
    v_xor_b32 v48, v12, v48
    v_mov_b32 v9, v48
    s_waitcnt vmcnt(2)
    v_xor_b32 v49, v12, v49
    v_or_b32 v9, v9, v49
    s_waitcnt vmcnt(1)
    v_xor_b32 v50, v12, v50
    v_or_b32 v9, v9, v50
    s_waitcnt vmcnt(0)
    v_xor_b32 v51, v12, v51
    v_or_b32 v9, v9, v51
    v_and_b32 v9, 0xff, v9
    v_cmp_ne_u32 vcc, 0, v9
    s_cbranch_vccnz Lpo_138
Lpd_139:
    ds_write_b128 v1, v[48:51] offset:17472
    s_mov_b32 s48, s30
    s_mov_b32 s49, s31
    s_mov_b32 s50, 4608
    s_mov_b32 s51, 0x20000
    ds_write_b128 v1, v[20:23] offset:16448
    ds_read_b32 v28, v11 offset:16448
    ds_read_b32 v29, v11 offset:17472
    s_lshl_b32 s52, s6, 3
    s_add_u32 s52, s52, s4
    s_mul_i32 s52, s52, 18432
    s_add_u32 s52, s52, 1257472
    s_add_u32 s53, s52, 4096
    s_add_u32 s54, s52, 8192
    s_add_u32 s55, s52, 12288
    s_add_u32 s56, s52, 16384
    s_lshl_b32 s57, s6, 7
    v_mov_b32 v30, s100
    s_waitcnt lgkmcnt(0)
    s_mov_b32 exec_lo, 0xff
    s_mov_b32 exec_hi, 0
    s_mov_b32 s62, 400000
Lpo_141:
    s_sub_u32 s62, s62, 1
    s_cbranch_scc1 Lpd_142
    buffer_load_dwordx4 v[64:67], v1, s[44:47], s52 offen offset:0 sc1
    s_waitcnt vmcnt(0)
    v_xor_b32 v64, s96, v64
    v_xor_b32 v65, s97, v65
    v_xor_b32 v66, s98, v66
    v_xor_b32 v67, s99, v67
    v_or3_b32 v5, v64, v65, v66
    v_or_b32 v5, v5, v67
    v_and_b32 v5, 0xff, v5
    v_cmp_ne_u32 vcc, 0, v5
    s_cbranch_vccnz Lpo_141
Lpd_142:
    s_mov_b64 exec, -1
    s_mov_b32 s62, 400000
Lpo_144:
    s_sub_u32 s62, s62, 1
    s_cbranch_scc1 Lpd_145
    buffer_load_dwordx4 v[64:67], v1, s[44:47], s52 offen offset:0 sc1
    buffer_load_dwordx4 v[68:71], v1, s[44:47], s52 offen offset:1024 sc1
    buffer_load_dwordx4 v[72:75], v1, s[44:47], s52 offen offset:2048 sc1
    buffer_load_dwordx4 v[76:79], v1, s[44:47], s52 offen offset:3072 sc1
    buffer_load_dwordx4 v[80:83], v1, s[44:47], s53 offen offset:0 sc1
    buffer_load_dwordx4 v[84:87], v1, s[44:47], s53 offen offset:1024 sc1
    buffer_load_dwordx4 v[88:91], v1, s[44:47], s53 offen offset:2048 sc1
    buffer_load_dwordx4 v[92:95], v1, s[44:47], s53 offen offset:3072 sc1
    buffer_load_dwordx4 v[96:99], v1, s[44:47], s54 offen offset:0 sc1
    buffer_load_dwordx4 v[100:103], v1, s[44:47], s54 offen offset:1024 sc1
    buffer_load_dwordx4 v[104:107], v1, s[44:47], s54 offen offset:2048 sc1
    buffer_load_dwordx4 v[108:111], v1, s[44:47], s54 offen offset:3072 sc1
    buffer_load_dwordx4 v[112:115], v1, s[44:47], s55 offen offset:0 sc1
    buffer_load_dwordx4 v[116:119], v1, s[44:47], s55 offen offset:1024 sc1
    buffer_load_dwordx4 v[120:123], v1, s[44:47], s55 offen offset:2048 sc1
    buffer_load_dwordx4 v[124:127], v1, s[44:47], s55 offen offset:3072 sc1
    buffer_load_dwordx4 v[128:131], v1, s[44:47], s56 offen offset:0 sc1
    buffer_load_dwordx4 v[132:135], v1, s[44:47], s56 offen offset:1024 sc1
    s_waitcnt vmcnt(17)
    v_xor_b32 v64, s96, v64
    v_xor_b32 v65, s97, v65
    v_xor_b32 v66, s98, v66
    v_xor_b32 v67, s99, v67
    v_or3_b32 v5, v64, v65, v66
    v_or_b32 v5, v5, v67
    s_waitcnt vmcnt(16)
    v_xor_b32 v68, s96, v68
    v_xor_b32 v69, s97, v69
    v_xor_b32 v70, s98, v70
    v_xor_b32 v71, s99, v71
    v_or3_b32 v5, v5, v68, v69
    v_or3_b32 v5, v5, v70, v71
    s_waitcnt vmcnt(15)
    v_xor_b32 v72, s96, v72
    v_xor_b32 v73, s97, v73
    v_xor_b32 v74, s98, v74
    v_xor_b32 v75, s99, v75
    v_or3_b32 v5, v5, v72, v73
    v_or3_b32 v5, v5, v74, v75
    s_waitcnt vmcnt(14)
    v_xor_b32 v76, s96, v76
    v_xor_b32 v77, s97, v77
    v_xor_b32 v78, s98, v78
    v_xor_b32 v79, s99, v79
    v_or3_b32 v5, v5, v76, v77
    v_or3_b32 v5, v5, v78, v79
    s_waitcnt vmcnt(13)
    v_xor_b32 v80, s96, v80
    v_xor_b32 v81, s97, v81
    v_xor_b32 v82, s98, v82
    v_xor_b32 v83, s99, v83
    v_or3_b32 v5, v5, v80, v81
    v_or3_b32 v5, v5, v82, v83
    s_waitcnt vmcnt(12)
    v_xor_b32 v84, s96, v84
    v_xor_b32 v85, s97, v85
    v_xor_b32 v86, s98, v86
    v_xor_b32 v87, s99, v87
    v_or3_b32 v5, v5, v84, v85
    v_or3_b32 v5, v5, v86, v87
    s_waitcnt vmcnt(11)
    v_xor_b32 v88, s96, v88
    v_xor_b32 v89, s97, v89
    v_xor_b32 v90, s98, v90
    v_xor_b32 v91, s99, v91
    v_or3_b32 v5, v5, v88, v89
    v_or3_b32 v5, v5, v90, v91
    s_waitcnt vmcnt(10)
    v_xor_b32 v92, s96, v92
    v_xor_b32 v93, s97, v93
    v_xor_b32 v94, s98, v94
    v_xor_b32 v95, s99, v95
    v_or3_b32 v5, v5, v92, v93
    v_or3_b32 v5, v5, v94, v95
    s_waitcnt vmcnt(9)
    v_xor_b32 v96, s96, v96
    v_xor_b32 v97, s97, v97
    v_xor_b32 v98, s98, v98
    v_xor_b32 v99, s99, v99
    v_or3_b32 v5, v5, v96, v97
    v_or3_b32 v5, v5, v98, v99
    s_waitcnt vmcnt(8)
    v_xor_b32 v100, s96, v100
    v_xor_b32 v101, s97, v101
    v_xor_b32 v102, s98, v102
    v_xor_b32 v103, s99, v103
    v_or3_b32 v5, v5, v100, v101
    v_or3_b32 v5, v5, v102, v103
    s_waitcnt vmcnt(7)
    v_xor_b32 v104, s96, v104
    v_xor_b32 v105, s97, v105
    v_xor_b32 v106, s98, v106
    v_xor_b32 v107, s99, v107
    v_or3_b32 v5, v5, v104, v105
    v_or3_b32 v5, v5, v106, v107
    s_waitcnt vmcnt(6)
    v_xor_b32 v108, s96, v108
    v_xor_b32 v109, s97, v109
    v_xor_b32 v110, s98, v110
    v_xor_b32 v111, s99, v111
    v_or3_b32 v5, v5, v108, v109
    v_or3_b32 v5, v5, v110, v111
    s_waitcnt vmcnt(5)
    v_xor_b32 v112, s96, v112
    v_xor_b32 v113, s97, v113
    v_xor_b32 v114, s98, v114
    v_xor_b32 v115, s99, v115
    v_or3_b32 v5, v5, v112, v113
    v_or3_b32 v5, v5, v114, v115
    s_waitcnt vmcnt(4)
    v_xor_b32 v116, s96, v116
    v_xor_b32 v117, s97, v117
    v_xor_b32 v118, s98, v118
    v_xor_b32 v119, s99, v119
    v_or3_b32 v5, v5, v116, v117
    v_or3_b32 v5, v5, v118, v119
    s_waitcnt vmcnt(3)
    v_xor_b32 v120, s96, v120
    v_xor_b32 v121, s97, v121
    v_xor_b32 v122, s98, v122
    v_xor_b32 v123, s99, v123
    v_or3_b32 v5, v5, v120, v121
    v_or3_b32 v5, v5, v122, v123
    s_waitcnt vmcnt(2)
    v_xor_b32 v124, s96, v124
    v_xor_b32 v125, s97, v125
    v_xor_b32 v126, s98, v126
    v_xor_b32 v127, s99, v127
    v_or3_b32 v5, v5, v124, v125
    v_or3_b32 v5, v5, v126, v127
    s_waitcnt vmcnt(1)
    v_xor_b32 v128, s96, v128
    v_xor_b32 v129, s97, v129
    v_xor_b32 v130, s98, v130
    v_xor_b32 v131, s99, v131
    v_or3_b32 v5, v5, v128, v129
    v_or3_b32 v5, v5, v130, v131
    s_waitcnt vmcnt(0)
    v_xor_b32 v132, s96, v132
    v_xor_b32 v133, s97, v133
    v_xor_b32 v134, s98, v134
    v_xor_b32 v135, s99, v135
    v_or3_b32 v5, v5, v132, v133
    v_or3_b32 v5, v5, v134, v135
    v_and_b32 v5, 0xff, v5
    v_cmp_ne_u32 vcc, 0, v5
    s_cbranch_vccnz Lpo_144
Lpd_145:
    v_pk_add_f32 v[64:65], v[64:65], v[68:69]
    v_pk_add_f32 v[66:67], v[66:67], v[70:71]
    v_pk_add_f32 v[72:73], v[72:73], v[76:77]
    v_pk_add_f32 v[74:75], v[74:75], v[78:79]
    v_pk_add_f32 v[80:81], v[80:81], v[84:85]
    v_pk_add_f32 v[82:83], v[82:83], v[86:87]
    v_pk_add_f32 v[88:89], v[88:89], v[92:93]
    v_pk_add_f32 v[90:91], v[90:91], v[94:95]
    v_pk_add_f32 v[96:97], v[96:97], v[100:101]
    v_pk_add_f32 v[98:99], v[98:99], v[102:103]
    v_pk_add_f32 v[104:105], v[104:105], v[108:109]
    v_pk_add_f32 v[106:107], v[106:107], v[110:111]
    v_pk_add_f32 v[112:113], v[112:113], v[116:117]
    v_pk_add_f32 v[114:115], v[114:115], v[118:119]
    v_pk_add_f32 v[120:121], v[120:121], v[124:125]
    v_pk_add_f32 v[122:123], v[122:123], v[126:127]
    v_pk_add_f32 v[128:129], v[128:129], v[132:133]
    v_pk_add_f32 v[130:131], v[130:131], v[134:135]
    v_pk_add_f32 v[64:65], v[64:65], v[72:73]
    v_pk_add_f32 v[66:67], v[66:67], v[74:75]
    v_pk_add_f32 v[80:81], v[80:81], v[88:89]
    v_pk_add_f32 v[82:83], v[82:83], v[90:91]
    v_pk_add_f32 v[96:97], v[96:97], v[104:105]
    v_pk_add_f32 v[98:99], v[98:99], v[106:107]
    v_pk_add_f32 v[112:113], v[112:113], v[120:121]
    v_pk_add_f32 v[114:115], v[114:115], v[122:123]
    v_pk_add_f32 v[64:65], v[64:65], v[80:81]
    v_pk_add_f32 v[66:67], v[66:67], v[82:83]
    v_pk_add_f32 v[96:97], v[96:97], v[112:113]
    v_pk_add_f32 v[98:99], v[98:99], v[114:115]
    v_pk_add_f32 v[64:65], v[64:65], v[96:97]
    v_pk_add_f32 v[66:67], v[66:67], v[98:99]
    v_pk_add_f32 v[20:21], v[64:65], v[128:129]
    v_pk_add_f32 v[22:23], v[66:67], v[130:131]
    s_nop 1
    v_permlane32_swap_b32 v20, v22
    v_permlane32_swap_b32 v21, v23
    v_pk_add_f32 v[20:21], v[20:21], v[22:23]
    s_nop 1
    v_permlane16_swap_b32 v20, v21
    v_add_f32 v20, v20, v21
    s_nop 1
    v_add_f32_dpp v20, v20, v20 row_ror:8 row_mask:0xf bank_mask:0xf
    v_cvt_pk_bf16_f32 v20, v20, v20
    v_lshlrev_b32 v20, 16, v20
    v_mul_f32 v20, v20, v29
    v_cvt_pk_bf16_f32 v20, v20, v20
    v_lshlrev_b32 v20, 16, v20
    v_add_f32 v20, v20, v28
    v_cvt_pk_bf16_f32 v20, v20, v20
    s_mov_b32 exec_lo, 0x00ff00ff
    s_mov_b32 exec_hi, 0x00ff00ff
    buffer_store_short v20, v10, s[48:51], s57 offen
    s_cmp_eq_u32 s2, 144
    s_cbranch_scc0 L_c_fin
    s_mov_b64 exec, 1
    buffer_store_dword v30, v15, s[44:47], 0 offen offset:0 sc1
L_c_fin:
    s_mov_b64 exec, -1
    s_endpgm
L_end:
    s_endpgm
L_exit:
    s_endpgm
L_codeend:
.fill (8*CODE_SLICE+1024-(L_codeend-adaLN_cond__sliding_block_cached__glu_gated_geglu__decode_kernel))/4, 4, 0xbf810000
.section .rodata,"a"
.p2align 6
.amdhsa_kernel adaLN_cond__sliding_block_cached__glu_gated_geglu__decode_kernel
  .amdhsa_next_free_vgpr 256
  .amdhsa_next_free_sgpr 102
  .amdhsa_accum_offset 256
  .amdhsa_group_segment_fixed_size 0
  .amdhsa_kernarg_size 112
  .amdhsa_user_sgpr_count 2
  .amdhsa_user_sgpr_kernarg_segment_ptr 1
  .amdhsa_system_sgpr_workgroup_id_x 1
  .amdhsa_float_denorm_mode_32 3
.end_amdhsa_kernel
```
